```python
import torch

def _softmax(x, axis=-1):
    return torch.softmax(x, dim=axis)
def _gelu(x):
    return torch.nn.functional.gelu(x, approximate="tanh")
def _silu(x):
    return torch.nn.functional.silu(x)
def _sigmoid(x):
    return torch.sigmoid(x)
def _layernorm(x, axis=-1, eps=1e-5):
    m = x.mean(dim=axis, keepdim=True)
    v = x.var(dim=axis, keepdim=True, unbiased=False)
    return (x - m) / torch.sqrt(v + eps)
def _scatter_add(tgt, idx, src, axis=0):
    return tgt.clone().index_add_(axis, idx, src)
def _segment_sum(src, seg, n):
    out = torch.zeros((n,) + src.shape[1:], dtype=src.dtype)
    return out.index_add_(0, seg, src)
def _pad(x, pw):
    flat = tuple(v for pair in reversed(pw) for v in pair)
    return torch.nn.functional.pad(x, flat)

kernel_name = 'concat_heads__grouped_kv_mqa__spectral_fnet__prompt'

def setup_inputs():

    _w = (lambda a: (lambda t: t.to(torch.bfloat16) if t.is_floating_point() else t)(torch.as_tensor(a)))
    def _A_setup():
        B, S, D, H = 1, 2048, 576, 32
        Dh = D // H
        return {
            "x": _w((lambda *s: torch.randn(*s, dtype=torch.bfloat16) * 0.05)(B, S, D)),
            "wq": _w((lambda *s: torch.randn(*s, dtype=torch.bfloat16) * 3.2)(D, H * Dh)),
            "wk": _w((lambda *s: torch.randn(*s, dtype=torch.bfloat16) * 3.2)(D, Dh)),
            "wv": _w((lambda *s: torch.randn(*s, dtype=torch.bfloat16) * 0.4)(D, Dh)),
            "wo": _w((lambda *s: torch.randn(*s, dtype=torch.bfloat16) * 0.4)(H * Dh, D)),
        }
    _A_in = _A_setup()

    def _B_setup():
        B, S, D = 1, 2048, 576
        ns = torch.arange(S)[:, None] * torch.arange(S)[None, :]
        nd = torch.arange(D)[:, None] * torch.arange(D)[None, :]
        Ws_re = torch.cos(-2.0 * torch.pi * ns / S).to(float)
        Ws_im = torch.sin(-2.0 * torch.pi * ns / S).to(float)
        Wd_re = torch.cos(-2.0 * torch.pi * nd / D).to(float)
        Wd_im = torch.sin(-2.0 * torch.pi * nd / D).to(float)
        return {
            "x": _w((lambda *s: torch.randn(*s, dtype=torch.bfloat16) * 0.05)(B, S, D)),
            "dft_seq_re": _w(Ws_re),
            "dft_seq_im": _w(Ws_im),
            "dft_hid_re": _w(Wd_re),
            "dft_hid_im": _w(Wd_im),
        }
    _B_in = _B_setup()

    return {
        "A_x": _A_in["x"],
        "A_wq": _A_in["wq"],
        "A_wk": _A_in["wk"],
        "A_wv": _A_in["wv"],
        "A_wo": _A_in["wo"],
        "B_x": _B_in["x"],
        "B_dft_seq_re": _B_in["dft_seq_re"],
        "B_dft_seq_im": _B_in["dft_seq_im"],
        "B_dft_hid_re": _B_in["dft_hid_re"],
        "B_dft_hid_im": _B_in["dft_hid_im"],
    }

def reference(A_x, A_wq, A_wk, A_wv, A_wo, B_x, B_dft_seq_re, B_dft_seq_im, B_dft_hid_re, B_dft_hid_im):
    def _A_ref(x, wq, wk, wv, wo):
        B, S, D = x.shape
        H = 32
        Dh = D // H
        q = (lambda x, *d: x.permute(*d))((x @ wq).reshape(B, S, H, Dh), 0, 2, 1, 3)
        k = x @ wk
        v = x @ wv
        scores = torch.einsum("bhqd,bkd->bhqk", q, k) * (Dh ** -0.5)
        p = _softmax(scores, axis=-1)
        o = torch.einsum("bhqk,bkd->bhqd", p, v)
        return (lambda x, *d: x.permute(*d))(o, 0, 2, 1, 3).reshape(B, S, H * Dh) @ wo

    def _B_ref(x, dft_seq_re, dft_seq_im, dft_hid_re, dft_hid_im):
        a = torch.einsum("bsd,ed->bse", x, dft_hid_re)
        b = torch.einsum("bsd,ed->bse", x, dft_hid_im)
        y = torch.einsum("ts,bse->bte", dft_seq_re, a) - torch.einsum("ts,bse->bte", dft_seq_im, b)
        return y

    a = _A_ref(A_x, A_wq, A_wk, A_wv, A_wo)
    b = _B_ref(B_x, B_dft_seq_re, B_dft_seq_im, B_dft_hid_re, B_dft_hid_im)
    return torch.concatenate([a, b], axis=-1)
```

```asm
; @launch kernel=k1_kernel grid=(256,1,1) block=(768,1,1) lds=163840
; @launch kernel=k2_kernel grid=(256,1,1) block=(768,1,1) lds=145408
.amdgcn_target "amdgcn-amd-amdhsa--gfx950"
.text
.globl k1_kernel
.p2align 8
.type k1_kernel,@function
k1_kernel:
    s_cmp_ge_u32 s2, 256
    s_cbranch_scc1 K1_exit
    s_load_dwordx4 s[4:7], s[0:1], 0
    s_load_dwordx4 s[8:11], s[0:1], 16
    s_load_dwordx2 s[12:13], s[0:1], 40
    s_load_dwordx2 s[14:15], s[0:1], 96
    s_load_dwordx2 s[88:89], s[0:1], 32
    s_load_dwordx8 s[92:99], s[0:1], 48
    v_and_b32 v1, 63, v0
    v_lshrrev_b32 v4, 6, v0
    v_mov_b32 v5, 161536
    v_readfirstlane_b32 s40, v4
    v_mov_b32 v6, 0
    v_mov_b32 v7, 0
    ds_write_b64 v5, v[6:7]
    v_mov_b32 v8, 9
    v_mov_b32 v9, 9
    ds_write_b64 v5, v[8:9] offset:8
    s_and_b32 s45, s2, 7
    s_lshl_b32 s45, s45, 5
    s_lshr_b32 s46, s2, 3
    s_add_u32 s43, s45, s46
    s_mul_i32 s41, s43, 7282
    s_lshr_b32 s41, s41, 16
    s_mul_i32 s45, s41, 9
    s_sub_u32 s42, s43, s45
    s_mul_i32 s58, s41, 74
    s_min_u32 s47, s58, 1974
    s_sub_u32 s58, s58, s47
    s_and_b32 s69, s41, 3
    s_lshl_b32 s69, s69, 1
    s_add_u32 s69, s69, s42
    s_sub_u32 s45, s69, 9
    s_cmp_ge_u32 s69, 9
    s_cselect_b32 s69, s45, s69
    s_waitcnt lgkmcnt(0)
    s_barrier
    s_mov_b32 s24, s14
    s_mov_b32 s25, s15
    s_mov_b32 s26, 0x6000000
    s_mov_b32 s27, 0x00020000
    s_cmp_ge_u32 s40, 9
    s_cbranch_scc1 K1_xf
    s_cmp_ge_u32 s43, 252
    s_cbranch_scc1 K1_spare
    s_cmp_ge_u32 s40, 2
    s_cbranch_scc1 K1_nold
    s_mov_b32 s49, 0
    s_cmp_eq_u32 s40, 1
    s_cbranch_scc1 K1_ldw
K1_ldx:
    s_mov_b32 s16, s4
    s_mov_b32 s17, s5
    s_mov_b32 s18, 0x240000
    s_mov_b32 s19, 0x00020000
    v_lshrrev_b32 v4, 3, v1
    v_lshrrev_b32 v5, 4, v1
    v_xor_b32 v5, v5, v1
    v_and_b32 v5, 7, v5
    v_lshlrev_b32 v5, 4, v5
    s_lshl_b32 s45, s49, 6
    v_xor_b32 v5, s45, v5
    v_mul_u32_u24 v4, 1152, v4
    v_add_u32 v11, v4, v5
    v_xor_b32 v5, 64, v5
    v_add_u32 v12, v4, v5
    s_mul_i32 s45, s49, 40
    s_add_u32 s71, s47, s45
    s_mul_i32 s71, s71, 1152
    s_mul_i32 s44, s49, 5120
    s_cmp_eq_u32 s49, 1
    s_cselect_b32 s56, -1, 0xffff
    s_cselect_b32 s57, -1, 0
    s_lshl_b32 s45, s49, 3
    s_add_u32 s45, s45, 161536
    v_mov_b32 v13, s45
    v_mov_b32 v14, 0
    s_mov_b32 s50, 0
K1_lx:
    s_lshl_b32 s45, s69, 7
    s_add_u32 s45, s45, s71
    s_add_u32 m0, s44, 0
    s_nop 0
    buffer_load_dwordx4 v11, s[16:19], s45 offen lds
    s_add_u32 m0, s44, 1024
    s_add_u32 s45, s45, 9216
    buffer_load_dwordx4 v12, s[16:19], s45 offen lds
    s_add_u32 m0, s44, 2048
    s_add_u32 s45, s45, 9216
    buffer_load_dwordx4 v11, s[16:19], s45 offen lds
    s_add_u32 m0, s44, 3072
    s_add_u32 s45, s45, 9216
    buffer_load_dwordx4 v12, s[16:19], s45 offen lds
    s_add_u32 m0, s44, 4096
    s_add_u32 s45, s45, 9216
    buffer_load_dwordx4 v11, s[16:19], s45 offen lds
    s_add_u32 m0, s44, 5120
    s_add_u32 s45, s45, 9216
    buffer_load_dwordx4 v12, s[16:19], s45 offen lds
    s_add_u32 m0, s44, 6144
    s_add_u32 s45, s45, 9216
    buffer_load_dwordx4 v11, s[16:19], s45 offen lds
    s_add_u32 m0, s44, 7168
    s_add_u32 s45, s45, 9216
    buffer_load_dwordx4 v12, s[16:19], s45 offen lds
    s_add_u32 m0, s44, 8192
    s_add_u32 s45, s45, 9216
    buffer_load_dwordx4 v11, s[16:19], s45 offen lds
    s_add_u32 m0, s44, 9216
    s_add_u32 s45, s45, 9216
    s_mov_b64 exec, s[56:57]
    buffer_load_dwordx4 v12, s[16:19], s45 offen lds
    s_mov_b64 exec, -1
    s_add_u32 s44, s44, 9472
    s_add_u32 s69, s69, 1
    s_cmp_eq_u32 s69, 9
    s_cselect_b32 s69, 0, s69
    s_add_u32 s50, s50, 1
    s_cmp_lt_u32 s50, 3
    s_cbranch_scc1 K1_lx
    v_add_u32 v14, 1, v14
    s_waitcnt vmcnt(20)
    ds_write_b32 v13, v14
    s_cmp_lt_u32 s50, 9
    s_cbranch_scc1 K1_lx
    v_add_u32 v14, 1, v14
    s_waitcnt vmcnt(10)
    ds_write_b32 v13, v14
    v_add_u32 v14, 1, v14
    s_waitcnt vmcnt(0)
    ds_write_b32 v13, v14
    s_branch K1_end
K1_ldw:
    s_mov_b32 s20, s6
    s_mov_b32 s21, s7
    s_mov_b32 s22, 0xa2000
    s_mov_b32 s23, 0x00020000
    v_lshrrev_b32 v4, 3, v1
    v_mul_u32_u24 v4, 1152, v4
    v_lshrrev_b32 v5, 2, v1
    v_and_b32 v5, 4, v5
    v_xor_b32 v5, v5, v1
    v_and_b32 v5, 7, v5
    v_lshlrev_b32 v5, 4, v5
    v_add_u32 v11, v4, v5
    s_lshl_b32 s71, s42, 7
    s_mul_i32 s45, s49, 36864
    s_add_u32 s71, s71, s45
    s_lshl_b32 s44, s49, 12
    s_add_u32 s44, s44, 85248
    s_lshl_b32 s45, s49, 3
    s_add_u32 s45, s45, 161540
    v_mov_b32 v13, s45
    v_mov_b32 v14, 0
    s_mov_b32 s50, 0
K1_lw:
    s_mul_i32 s45, s69, 73728
    s_add_u32 s45, s45, s71
    s_add_u32 m0, s44, 0
    s_nop 0
    buffer_load_dwordx4 v11, s[20:23], s45 offen lds
    s_add_u32 m0, s44, 1024
    s_add_u32 s45, s45, 9216
    buffer_load_dwordx4 v11, s[20:23], s45 offen lds
    s_add_u32 m0, s44, 2048
    s_add_u32 s45, s45, 9216
    buffer_load_dwordx4 v11, s[20:23], s45 offen lds
    s_add_u32 m0, s44, 3072
    s_add_u32 s45, s45, 9216
    buffer_load_dwordx4 v11, s[20:23], s45 offen lds
    s_add_u32 m0, s44, 4096
    s_add_u32 s45, s45, 9216
    buffer_load_dwordx4 v11, s[20:23], s45 offen lds
    s_add_u32 m0, s44, 5120
    s_add_u32 s45, s45, 9216
    buffer_load_dwordx4 v11, s[20:23], s45 offen lds
    s_add_u32 m0, s44, 6144
    s_add_u32 s45, s45, 9216
    buffer_load_dwordx4 v11, s[20:23], s45 offen lds
    s_add_u32 m0, s44, 7168
    s_add_u32 s45, s45, 9216
    buffer_load_dwordx4 v11, s[20:23], s45 offen lds
    s_add_u32 s44, s44, 8192
    s_add_u32 s69, s69, 1
    s_cmp_eq_u32 s69, 9
    s_cselect_b32 s69, 0, s69
    s_add_u32 s50, s50, 1
    s_cmp_lt_u32 s50, 3
    s_cbranch_scc1 K1_lw
    v_add_u32 v14, 1, v14
    s_waitcnt vmcnt(16)
    ds_write_b32 v13, v14
    s_cmp_lt_u32 s50, 9
    s_cbranch_scc1 K1_lw
    v_add_u32 v14, 1, v14
    s_waitcnt vmcnt(8)
    ds_write_b32 v13, v14
    v_add_u32 v14, 1, v14
    s_waitcnt vmcnt(0)
    ds_write_b32 v13, v14
    s_branch K1_end
K1_nold:
    s_sub_u32 s45, s40, 2
    s_and_b32 s49, s45, 1
    s_lshr_b32 s48, s45, 1
    s_cmp_lg_u32 s40, 8
    s_cbranch_scc1 K1_c1
    s_cmp_ge_u32 s42, 6
    s_cbranch_scc1 K1_end
    s_cmp_ge_u32 s42, 3
    s_cselect_b32 s49, 1, 0
    s_mul_i32 s45, s49, 3
    s_sub_u32 s48, s42, s45
K1_c1:
    v_and_b32 v34, 31, v1
    v_lshrrev_b32 v35, 5, v1
    s_lshl_b32 s45, s48, 5
    v_add_u32 v34, s45, v34
    v_lshrrev_b32 v4, 1, v34
    v_and_b32 v4, 7, v4
    v_xor_b32 v4, v4, v35
    v_lshlrev_b32 v5, 7, v34
    v_xor_b32 v6, 0, v4
    v_lshlrev_b32 v6, 4, v6
    v_add_u32 v8, v5, v6
    v_xor_b32 v6, 2, v4
    v_lshlrev_b32 v6, 4, v6
    v_add_u32 v9, v5, v6
    v_xor_b32 v6, 4, v4
    v_lshlrev_b32 v6, 4, v6
    v_add_u32 v10, v5, v6
    v_xor_b32 v6, 6, v4
    v_lshlrev_b32 v6, 4, v6
    v_add_u32 v11, v5, v6
    v_bfe_u32 v4, v1, 2, 2
    v_lshlrev_b32 v5, 3, v35
    v_add_u32 v4, v4, v5
    v_bfe_u32 v5, v1, 4, 1
    v_lshlrev_b32 v5, 5, v5
    v_and_b32 v6, 3, v1
    v_lshlrev_b32 v6, 3, v6
    v_add_u32 v5, v5, v6
    v_mov_b32 v2, 161536
    s_mov_b32 s51, 0
    v_mov_b32 v16, 0
    v_mov_b32 v17, 0
    v_mov_b32 v18, 0
    v_mov_b32 v19, 0
    v_mov_b32 v20, 0
    v_mov_b32 v21, 0
    v_mov_b32 v22, 0
    v_mov_b32 v23, 0
    v_mov_b32 v24, 0
    v_mov_b32 v25, 0
    v_mov_b32 v26, 0
    v_mov_b32 v27, 0
    v_mov_b32 v28, 0
    v_mov_b32 v29, 0
    v_mov_b32 v30, 0
    v_mov_b32 v31, 0
    s_cmp_eq_u32 s40, 8
    s_cbranch_scc1 K1_kv
    v_lshlrev_b32 v12, 7, v4
    s_lshl_b32 s45, s49, 6
    v_add_u32 v5, s45, v5
    v_and_b32 v6, 8, v1
    v_lshlrev_b32 v6, 3, v6
    v_xor_b32 v5, v5, v6
    v_add_u32 v12, v12, v5
    v_add_u32 v12, 85248, v12
    v_add_u32 v4, s47, v34
    v_mul_u32_u24 v4, 1152, v4
    v_lshlrev_b32 v5, 4, v35
    v_add_u32 v4, v4, v5
    v_mov_b32 v5, 0x40000000
    v_cmp_lt_u32 vcc, 73, v34
    s_nop 1
    v_cndmask_b32 v4, v4, v5, vcc
    v_cmp_gt_u32 vcc, s58, v34
    s_nop 1
    v_cndmask_b32 v4, v4, v5, vcc
    s_cmp_gt_u32 s51, 0
    s_cbranch_scc1 K1_qrd0
K1_qpw0:
    ds_read_b128 v[96:99], v2
    s_waitcnt lgkmcnt(0)
    v_min_u32 v6, v96, v97
    v_min3_u32 v6, v6, v98, v99
    s_nop 0
    v_readfirstlane_b32 s51, v6
    s_cmp_gt_u32 s51, 0
    s_cbranch_scc0 K1_qpw0
K1_qrd0:
    ds_read_b128 v[36:39], v8 offset:0
    ds_read_b64_tr_b16 v[52:53], v12 offset:0
    ds_read_b64_tr_b16 v[54:55], v12 offset:512
    ds_read_b128 v[40:43], v9 offset:0
    ds_read_b64_tr_b16 v[56:57], v12 offset:2048
    ds_read_b64_tr_b16 v[58:59], v12 offset:2560
    ds_read_b128 v[44:47], v10 offset:0
    ds_read_b64_tr_b16 v[60:61], v12 offset:4096
    ds_read_b64_tr_b16 v[62:63], v12 offset:4608
    ds_read_b128 v[48:51], v11 offset:0
    ds_read_b64_tr_b16 v[64:65], v12 offset:6144
    ds_read_b64_tr_b16 v[66:67], v12 offset:6656
    v_add_u32 v12, 8192, v12
    s_cmp_gt_u32 s51, 1
    s_cbranch_scc1 K1_qrd1
K1_qpw1:
    ds_read_b128 v[96:99], v2
    s_waitcnt lgkmcnt(0)
    v_min_u32 v6, v96, v97
    v_min3_u32 v6, v6, v98, v99
    s_nop 0
    v_readfirstlane_b32 s51, v6
    s_cmp_gt_u32 s51, 1
    s_cbranch_scc0 K1_qpw1
K1_qrd1:
    s_waitcnt lgkmcnt(0)
    ds_read_b128 v[100:103], v8 offset:9472
    ds_read_b64_tr_b16 v[116:117], v12 offset:0
    ds_read_b64_tr_b16 v[118:119], v12 offset:512
    v_mfma_f32_32x32x16_bf16 v[16:31], v[52:55], v[36:39], v[16:31]
    ds_read_b128 v[104:107], v9 offset:9472
    ds_read_b64_tr_b16 v[120:121], v12 offset:2048
    ds_read_b64_tr_b16 v[122:123], v12 offset:2560
    v_mfma_f32_32x32x16_bf16 v[16:31], v[56:59], v[40:43], v[16:31]
    ds_read_b128 v[108:111], v10 offset:9472
    ds_read_b64_tr_b16 v[124:125], v12 offset:4096
    ds_read_b64_tr_b16 v[126:127], v12 offset:4608
    v_mfma_f32_32x32x16_bf16 v[16:31], v[60:63], v[44:47], v[16:31]
    ds_read_b128 v[112:115], v11 offset:9472
    ds_read_b64_tr_b16 v[128:129], v12 offset:6144
    ds_read_b64_tr_b16 v[130:131], v12 offset:6656
    v_mfma_f32_32x32x16_bf16 v[16:31], v[64:67], v[48:51], v[16:31]
    v_add_u32 v12, 8192, v12
    s_cmp_gt_u32 s51, 2
    s_cbranch_scc1 K1_qrd2
K1_qpw2:
    ds_read_b128 v[96:99], v2
    s_waitcnt lgkmcnt(0)
    v_min_u32 v6, v96, v97
    v_min3_u32 v6, v6, v98, v99
    s_nop 0
    v_readfirstlane_b32 s51, v6
    s_cmp_gt_u32 s51, 2
    s_cbranch_scc0 K1_qpw2
K1_qrd2:
    s_waitcnt lgkmcnt(0)
    ds_read_b128 v[36:39], v8 offset:18944
    ds_read_b64_tr_b16 v[52:53], v12 offset:0
    ds_read_b64_tr_b16 v[54:55], v12 offset:512
    v_mfma_f32_32x32x16_bf16 v[16:31], v[116:119], v[100:103], v[16:31]
    ds_read_b128 v[40:43], v9 offset:18944
    ds_read_b64_tr_b16 v[56:57], v12 offset:2048
    ds_read_b64_tr_b16 v[58:59], v12 offset:2560
    v_mfma_f32_32x32x16_bf16 v[16:31], v[120:123], v[104:107], v[16:31]
    ds_read_b128 v[44:47], v10 offset:18944
    ds_read_b64_tr_b16 v[60:61], v12 offset:4096
    ds_read_b64_tr_b16 v[62:63], v12 offset:4608
    v_mfma_f32_32x32x16_bf16 v[16:31], v[124:127], v[108:111], v[16:31]
    ds_read_b128 v[48:51], v11 offset:18944
    ds_read_b64_tr_b16 v[64:65], v12 offset:6144
    ds_read_b64_tr_b16 v[66:67], v12 offset:6656
    v_mfma_f32_32x32x16_bf16 v[16:31], v[128:131], v[112:115], v[16:31]
    v_add_u32 v12, 8192, v12
    s_cmp_gt_u32 s51, 3
    s_cbranch_scc1 K1_qrd3
K1_qpw3:
    ds_read_b128 v[96:99], v2
    s_waitcnt lgkmcnt(0)
    v_min_u32 v6, v96, v97
    v_min3_u32 v6, v6, v98, v99
    s_nop 0
    v_readfirstlane_b32 s51, v6
    s_cmp_gt_u32 s51, 3
    s_cbranch_scc0 K1_qpw3
K1_qrd3:
    s_waitcnt lgkmcnt(0)
    ds_read_b128 v[100:103], v8 offset:28416
    ds_read_b64_tr_b16 v[116:117], v12 offset:0
    ds_read_b64_tr_b16 v[118:119], v12 offset:512
    v_mfma_f32_32x32x16_bf16 v[16:31], v[52:55], v[36:39], v[16:31]
    ds_read_b128 v[104:107], v9 offset:28416
    ds_read_b64_tr_b16 v[120:121], v12 offset:2048
    ds_read_b64_tr_b16 v[122:123], v12 offset:2560
    v_mfma_f32_32x32x16_bf16 v[16:31], v[56:59], v[40:43], v[16:31]
    ds_read_b128 v[108:111], v10 offset:28416
    ds_read_b64_tr_b16 v[124:125], v12 offset:4096
    ds_read_b64_tr_b16 v[126:127], v12 offset:4608
    v_mfma_f32_32x32x16_bf16 v[16:31], v[60:63], v[44:47], v[16:31]
    ds_read_b128 v[112:115], v11 offset:28416
    ds_read_b64_tr_b16 v[128:129], v12 offset:6144
    ds_read_b64_tr_b16 v[130:131], v12 offset:6656
    v_mfma_f32_32x32x16_bf16 v[16:31], v[64:67], v[48:51], v[16:31]
    v_add_u32 v12, 8192, v12
    s_cmp_gt_u32 s51, 4
    s_cbranch_scc1 K1_qrd4
K1_qpw4:
    ds_read_b128 v[96:99], v2
    s_waitcnt lgkmcnt(0)
    v_min_u32 v6, v96, v97
    v_min3_u32 v6, v6, v98, v99
    s_nop 0
    v_readfirstlane_b32 s51, v6
    s_cmp_gt_u32 s51, 4
    s_cbranch_scc0 K1_qpw4
K1_qrd4:
    s_waitcnt lgkmcnt(0)
    ds_read_b128 v[36:39], v8 offset:37888
    ds_read_b64_tr_b16 v[52:53], v12 offset:0
    ds_read_b64_tr_b16 v[54:55], v12 offset:512
    v_mfma_f32_32x32x16_bf16 v[16:31], v[116:119], v[100:103], v[16:31]
    ds_read_b128 v[40:43], v9 offset:37888
    ds_read_b64_tr_b16 v[56:57], v12 offset:2048
    ds_read_b64_tr_b16 v[58:59], v12 offset:2560
    v_mfma_f32_32x32x16_bf16 v[16:31], v[120:123], v[104:107], v[16:31]
    ds_read_b128 v[44:47], v10 offset:37888
    ds_read_b64_tr_b16 v[60:61], v12 offset:4096
    ds_read_b64_tr_b16 v[62:63], v12 offset:4608
    v_mfma_f32_32x32x16_bf16 v[16:31], v[124:127], v[108:111], v[16:31]
    ds_read_b128 v[48:51], v11 offset:37888
    ds_read_b64_tr_b16 v[64:65], v12 offset:6144
    ds_read_b64_tr_b16 v[66:67], v12 offset:6656
    v_mfma_f32_32x32x16_bf16 v[16:31], v[128:131], v[112:115], v[16:31]
    v_add_u32 v12, 8192, v12
    s_cmp_gt_u32 s51, 5
    s_cbranch_scc1 K1_qrd5
K1_qpw5:
    ds_read_b128 v[96:99], v2
    s_waitcnt lgkmcnt(0)
    v_min_u32 v6, v96, v97
    v_min3_u32 v6, v6, v98, v99
    s_nop 0
    v_readfirstlane_b32 s51, v6
    s_cmp_gt_u32 s51, 5
    s_cbranch_scc0 K1_qpw5
K1_qrd5:
    s_waitcnt lgkmcnt(0)
    ds_read_b128 v[100:103], v8 offset:47360
    ds_read_b64_tr_b16 v[116:117], v12 offset:0
    ds_read_b64_tr_b16 v[118:119], v12 offset:512
    v_mfma_f32_32x32x16_bf16 v[16:31], v[52:55], v[36:39], v[16:31]
    ds_read_b128 v[104:107], v9 offset:47360
    ds_read_b64_tr_b16 v[120:121], v12 offset:2048
    ds_read_b64_tr_b16 v[122:123], v12 offset:2560
    v_mfma_f32_32x32x16_bf16 v[16:31], v[56:59], v[40:43], v[16:31]
    ds_read_b128 v[108:111], v10 offset:47360
    ds_read_b64_tr_b16 v[124:125], v12 offset:4096
    ds_read_b64_tr_b16 v[126:127], v12 offset:4608
    v_mfma_f32_32x32x16_bf16 v[16:31], v[60:63], v[44:47], v[16:31]
    ds_read_b128 v[112:115], v11 offset:47360
    ds_read_b64_tr_b16 v[128:129], v12 offset:6144
    ds_read_b64_tr_b16 v[130:131], v12 offset:6656
    v_mfma_f32_32x32x16_bf16 v[16:31], v[64:67], v[48:51], v[16:31]
    v_add_u32 v12, 8192, v12
    s_cmp_gt_u32 s51, 6
    s_cbranch_scc1 K1_qrd6
K1_qpw6:
    ds_read_b128 v[96:99], v2
    s_waitcnt lgkmcnt(0)
    v_min_u32 v6, v96, v97
    v_min3_u32 v6, v6, v98, v99
    s_nop 0
    v_readfirstlane_b32 s51, v6
    s_cmp_gt_u32 s51, 6
    s_cbranch_scc0 K1_qpw6
K1_qrd6:
    v_add_u32 v8, 56832, v8
    v_add_u32 v9, 56832, v9
    v_add_u32 v10, 56832, v10
    v_add_u32 v11, 56832, v11
    s_waitcnt lgkmcnt(0)
    ds_read_b128 v[36:39], v8 offset:0
    ds_read_b64_tr_b16 v[52:53], v12 offset:0
    ds_read_b64_tr_b16 v[54:55], v12 offset:512
    v_mfma_f32_32x32x16_bf16 v[16:31], v[116:119], v[100:103], v[16:31]
    ds_read_b128 v[40:43], v9 offset:0
    ds_read_b64_tr_b16 v[56:57], v12 offset:2048
    ds_read_b64_tr_b16 v[58:59], v12 offset:2560
    v_mfma_f32_32x32x16_bf16 v[16:31], v[120:123], v[104:107], v[16:31]
    ds_read_b128 v[44:47], v10 offset:0
    ds_read_b64_tr_b16 v[60:61], v12 offset:4096
    ds_read_b64_tr_b16 v[62:63], v12 offset:4608
    v_mfma_f32_32x32x16_bf16 v[16:31], v[124:127], v[108:111], v[16:31]
    ds_read_b128 v[48:51], v11 offset:0
    ds_read_b64_tr_b16 v[64:65], v12 offset:6144
    ds_read_b64_tr_b16 v[66:67], v12 offset:6656
    v_mfma_f32_32x32x16_bf16 v[16:31], v[128:131], v[112:115], v[16:31]
    v_add_u32 v12, 8192, v12
    s_cmp_gt_u32 s51, 7
    s_cbranch_scc1 K1_qrd7
K1_qpw7:
    ds_read_b128 v[96:99], v2
    s_waitcnt lgkmcnt(0)
    v_min_u32 v6, v96, v97
    v_min3_u32 v6, v6, v98, v99
    s_nop 0
    v_readfirstlane_b32 s51, v6
    s_cmp_gt_u32 s51, 7
    s_cbranch_scc0 K1_qpw7
K1_qrd7:
    s_waitcnt lgkmcnt(0)
    ds_read_b128 v[100:103], v8 offset:9472
    ds_read_b64_tr_b16 v[116:117], v12 offset:0
    ds_read_b64_tr_b16 v[118:119], v12 offset:512
    v_mfma_f32_32x32x16_bf16 v[16:31], v[52:55], v[36:39], v[16:31]
    ds_read_b128 v[104:107], v9 offset:9472
    ds_read_b64_tr_b16 v[120:121], v12 offset:2048
    ds_read_b64_tr_b16 v[122:123], v12 offset:2560
    v_mfma_f32_32x32x16_bf16 v[16:31], v[56:59], v[40:43], v[16:31]
    ds_read_b128 v[108:111], v10 offset:9472
    ds_read_b64_tr_b16 v[124:125], v12 offset:4096
    ds_read_b64_tr_b16 v[126:127], v12 offset:4608
    v_mfma_f32_32x32x16_bf16 v[16:31], v[60:63], v[44:47], v[16:31]
    ds_read_b128 v[112:115], v11 offset:9472
    ds_read_b64_tr_b16 v[128:129], v12 offset:6144
    ds_read_b64_tr_b16 v[130:131], v12 offset:6656
    v_mfma_f32_32x32x16_bf16 v[16:31], v[64:67], v[48:51], v[16:31]
    v_add_u32 v12, 8192, v12
    s_cmp_gt_u32 s51, 8
    s_cbranch_scc1 K1_qrd8
K1_qpw8:
    ds_read_b128 v[96:99], v2
    s_waitcnt lgkmcnt(0)
    v_min_u32 v6, v96, v97
    v_min3_u32 v6, v6, v98, v99
    s_nop 0
    v_readfirstlane_b32 s51, v6
    s_cmp_gt_u32 s51, 8
    s_cbranch_scc0 K1_qpw8
K1_qrd8:
    s_waitcnt lgkmcnt(0)
    ds_read_b128 v[36:39], v8 offset:18944
    ds_read_b64_tr_b16 v[52:53], v12 offset:0
    ds_read_b64_tr_b16 v[54:55], v12 offset:512
    v_mfma_f32_32x32x16_bf16 v[16:31], v[116:119], v[100:103], v[16:31]
    ds_read_b128 v[40:43], v9 offset:18944
    ds_read_b64_tr_b16 v[56:57], v12 offset:2048
    ds_read_b64_tr_b16 v[58:59], v12 offset:2560
    v_mfma_f32_32x32x16_bf16 v[16:31], v[120:123], v[104:107], v[16:31]
    ds_read_b128 v[44:47], v10 offset:18944
    ds_read_b64_tr_b16 v[60:61], v12 offset:4096
    ds_read_b64_tr_b16 v[62:63], v12 offset:4608
    v_mfma_f32_32x32x16_bf16 v[16:31], v[124:127], v[108:111], v[16:31]
    ds_read_b128 v[48:51], v11 offset:18944
    ds_read_b64_tr_b16 v[64:65], v12 offset:6144
    ds_read_b64_tr_b16 v[66:67], v12 offset:6656
    v_mfma_f32_32x32x16_bf16 v[16:31], v[128:131], v[112:115], v[16:31]
    v_add_u32 v12, 8192, v12
    s_waitcnt lgkmcnt(9)
    v_mfma_f32_32x32x16_bf16 v[16:31], v[52:55], v[36:39], v[16:31]
    s_waitcnt lgkmcnt(6)
    v_mfma_f32_32x32x16_bf16 v[16:31], v[56:59], v[40:43], v[16:31]
    s_waitcnt lgkmcnt(3)
    v_mfma_f32_32x32x16_bf16 v[16:31], v[60:63], v[44:47], v[16:31]
    s_waitcnt lgkmcnt(0)
    v_mfma_f32_32x32x16_bf16 v[16:31], v[64:67], v[48:51], v[16:31]
    s_mov_b32 s46, 0x3eae1a93
    s_lshl_b32 s45, s42, 7
    s_lshl_b32 s50, s49, 6
    s_add_u32 s45, s45, s50
    s_nop 7
    v_mul_f32 v16, s46, v16
    v_mul_f32 v17, s46, v17
    v_mul_f32 v18, s46, v18
    v_mul_f32 v19, s46, v19
    v_mul_f32 v20, s46, v20
    v_mul_f32 v21, s46, v21
    v_mul_f32 v22, s46, v22
    v_mul_f32 v23, s46, v23
    v_mul_f32 v24, s46, v24
    v_mul_f32 v25, s46, v25
    v_mul_f32 v26, s46, v26
    v_mul_f32 v27, s46, v27
    v_mul_f32 v28, s46, v28
    v_mul_f32 v29, s46, v29
    v_mul_f32 v30, s46, v30
    v_mul_f32 v31, s46, v31
    v_cvt_pk_bf16_f32 v68, v16, v17
    v_cvt_pk_bf16_f32 v69, v18, v19
    v_cvt_pk_bf16_f32 v70, v20, v21
    v_cvt_pk_bf16_f32 v71, v22, v23
    v_cvt_pk_bf16_f32 v72, v24, v25
    v_cvt_pk_bf16_f32 v73, v26, v27
    v_cvt_pk_bf16_f32 v74, v28, v29
    v_cvt_pk_bf16_f32 v75, v30, v31
    v_permlane32_swap_b32 v68, v70
    v_permlane32_swap_b32 v69, v71
    v_permlane32_swap_b32 v72, v74
    v_permlane32_swap_b32 v73, v75
    buffer_store_dwordx4 v[68:71], v4, s[24:27], s45 offen offset:0
    buffer_store_dwordx4 v[72:75], v4, s[24:27], s45 offen offset:32
    s_branch K1_end
K1_kv:
    s_setprio 3
    s_cmp_eq_u32 s49, 0
    s_cselect_b32 s28, s8, s10
    s_cselect_b32 s29, s9, s11
    s_mov_b32 s30, 20736
    s_mov_b32 s31, 0x00020000
    v_mul_u32_u24 v12, 40, v4
    v_add_u32 v12, v12, v5
    v_add_u32 v12, 158976, v12
    v_mul_u32_u24 v4, 12, v1
    s_mul_i32 s45, s69, 2304
    buffer_load_dwordx3 v[68:70], v4, s[28:31], s45 offen
    buffer_load_dwordx3 v[72:74], v4, s[28:31], s45 offen offset:768
    buffer_load_dwordx3 v[76:78], v4, s[28:31], s45 offen offset:1536
    s_add_u32 s69, s69, 1
    s_cmp_eq_u32 s69, 9
    s_cselect_b32 s69, 0, s69
    s_mul_i32 s45, s69, 2304
    buffer_load_dwordx3 v[80:82], v4, s[28:31], s45 offen
    buffer_load_dwordx3 v[84:86], v4, s[28:31], s45 offen offset:768
    buffer_load_dwordx3 v[88:90], v4, s[28:31], s45 offen offset:1536
    s_add_u32 s69, s69, 1
    s_cmp_eq_u32 s69, 9
    s_cselect_b32 s69, 0, s69
    s_mul_i32 s45, s69, 2304
    buffer_load_dwordx3 v[132:134], v4, s[28:31], s45 offen
    buffer_load_dwordx3 v[136:138], v4, s[28:31], s45 offen offset:768
    buffer_load_dwordx3 v[140:142], v4, s[28:31], s45 offen offset:1536
    s_add_u32 s69, s69, 1
    s_cmp_eq_u32 s69, 9
    s_cselect_b32 s69, 0, s69
    s_mul_i32 s45, s69, 2304
    buffer_load_dwordx3 v[144:146], v4, s[28:31], s45 offen
    buffer_load_dwordx3 v[148:150], v4, s[28:31], s45 offen offset:768
    buffer_load_dwordx3 v[152:154], v4, s[28:31], s45 offen offset:1536
    s_add_u32 s69, s69, 1
    s_cmp_eq_u32 s69, 9
    s_cselect_b32 s69, 0, s69
    s_mul_i32 s45, s69, 2304
    buffer_load_dwordx3 v[156:158], v4, s[28:31], s45 offen
    buffer_load_dwordx3 v[160:162], v4, s[28:31], s45 offen offset:768
    buffer_load_dwordx3 v[164:166], v4, s[28:31], s45 offen offset:1536
    s_add_u32 s69, s69, 1
    s_cmp_eq_u32 s69, 9
    s_cselect_b32 s69, 0, s69
    v_add_u32 v6, 0, v1
    v_mul_u32_u24 v7, 21846, v6
    v_lshrrev_b32 v7, 16, v7
    v_lshlrev_b32 v7, 2, v7
    v_mul_u32_u24 v6, 12, v6
    v_add_u32 v6, v6, v7
    v_add_u32 v92, 158976, v6
    v_add_u32 v6, 64, v1
    v_mul_u32_u24 v7, 21846, v6
    v_lshrrev_b32 v7, 16, v7
    v_lshlrev_b32 v7, 2, v7
    v_mul_u32_u24 v6, 12, v6
    v_add_u32 v6, v6, v7
    v_add_u32 v93, 158976, v6
    v_add_u32 v6, 128, v1
    v_mul_u32_u24 v7, 21846, v6
    v_lshrrev_b32 v7, 16, v7
    v_lshlrev_b32 v7, 2, v7
    v_mul_u32_u24 v6, 12, v6
    v_add_u32 v6, v6, v7
    v_add_u32 v94, 158976, v6
    s_waitcnt vmcnt(12)
    ds_write2_b32 v92, v68, v69 offset0:0 offset1:1
    ds_write_b32 v92, v70 offset:8
    ds_write2_b32 v93, v72, v73 offset0:0 offset1:1
    ds_write_b32 v93, v74 offset:8
    ds_write2_b32 v94, v76, v77 offset0:0 offset1:1
    ds_write_b32 v94, v78 offset:8
    s_waitcnt lgkmcnt(0)
    s_mul_i32 s45, s69, 2304
    buffer_load_dwordx3 v[68:70], v4, s[28:31], s45 offen
    buffer_load_dwordx3 v[72:74], v4, s[28:31], s45 offen offset:768
    buffer_load_dwordx3 v[76:78], v4, s[28:31], s45 offen offset:1536
    s_add_u32 s69, s69, 1
    s_cmp_eq_u32 s69, 9
    s_cselect_b32 s69, 0, s69
    s_cmp_gt_u32 s51, 0
    s_cbranch_scc1 K1_krd0
K1_kpw0:
    ds_read_b128 v[96:99], v2
    s_waitcnt lgkmcnt(0)
    v_min_u32 v6, v96, v97
    v_min3_u32 v6, v6, v98, v99
    s_nop 0
    v_readfirstlane_b32 s51, v6
    s_cmp_gt_u32 s51, 0
    s_cbranch_scc0 K1_kpw0
K1_krd0:
    ds_read_b128 v[36:39], v8 offset:0
    ds_read_b64_tr_b16 v[52:53], v12 offset:0
    ds_read_b64_tr_b16 v[54:55], v12 offset:160
    ds_read_b128 v[40:43], v9 offset:0
    ds_read_b64_tr_b16 v[56:57], v12 offset:640
    ds_read_b64_tr_b16 v[58:59], v12 offset:800
    ds_read_b128 v[44:47], v10 offset:0
    ds_read_b64_tr_b16 v[60:61], v12 offset:1280
    ds_read_b64_tr_b16 v[62:63], v12 offset:1440
    ds_read_b128 v[48:51], v11 offset:0
    ds_read_b64_tr_b16 v[64:65], v12 offset:1920
    ds_read_b64_tr_b16 v[66:67], v12 offset:2080
    s_waitcnt vmcnt(12)
    ds_write2_b32 v92, v80, v81 offset0:0 offset1:1
    ds_write_b32 v92, v82 offset:8
    ds_write2_b32 v93, v84, v85 offset0:0 offset1:1
    ds_write_b32 v93, v86 offset:8
    ds_write2_b32 v94, v88, v89 offset0:0 offset1:1
    ds_write_b32 v94, v90 offset:8
    s_waitcnt lgkmcnt(0)
    s_mul_i32 s45, s69, 2304
    buffer_load_dwordx3 v[80:82], v4, s[28:31], s45 offen
    buffer_load_dwordx3 v[84:86], v4, s[28:31], s45 offen offset:768
    buffer_load_dwordx3 v[88:90], v4, s[28:31], s45 offen offset:1536
    s_add_u32 s69, s69, 1
    s_cmp_eq_u32 s69, 9
    s_cselect_b32 s69, 0, s69
    s_cmp_gt_u32 s51, 1
    s_cbranch_scc1 K1_krd1
K1_kpw1:
    ds_read_b128 v[96:99], v2
    s_waitcnt lgkmcnt(0)
    v_min_u32 v6, v96, v97
    v_min3_u32 v6, v6, v98, v99
    s_nop 0
    v_readfirstlane_b32 s51, v6
    s_cmp_gt_u32 s51, 1
    s_cbranch_scc0 K1_kpw1
K1_krd1:
    s_waitcnt lgkmcnt(0)
    ds_read_b128 v[100:103], v8 offset:9472
    ds_read_b64_tr_b16 v[116:117], v12 offset:0
    ds_read_b64_tr_b16 v[118:119], v12 offset:160
    v_mfma_f32_32x32x16_bf16 v[16:31], v[52:55], v[36:39], v[16:31]
    ds_read_b128 v[104:107], v9 offset:9472
    ds_read_b64_tr_b16 v[120:121], v12 offset:640
    ds_read_b64_tr_b16 v[122:123], v12 offset:800
    v_mfma_f32_32x32x16_bf16 v[16:31], v[56:59], v[40:43], v[16:31]
    ds_read_b128 v[108:111], v10 offset:9472
    ds_read_b64_tr_b16 v[124:125], v12 offset:1280
    ds_read_b64_tr_b16 v[126:127], v12 offset:1440
    v_mfma_f32_32x32x16_bf16 v[16:31], v[60:63], v[44:47], v[16:31]
    ds_read_b128 v[112:115], v11 offset:9472
    ds_read_b64_tr_b16 v[128:129], v12 offset:1920
    ds_read_b64_tr_b16 v[130:131], v12 offset:2080
    v_mfma_f32_32x32x16_bf16 v[16:31], v[64:67], v[48:51], v[16:31]
    s_waitcnt vmcnt(12)
    ds_write2_b32 v92, v132, v133 offset0:0 offset1:1
    ds_write_b32 v92, v134 offset:8
    ds_write2_b32 v93, v136, v137 offset0:0 offset1:1
    ds_write_b32 v93, v138 offset:8
    ds_write2_b32 v94, v140, v141 offset0:0 offset1:1
    ds_write_b32 v94, v142 offset:8
    s_waitcnt lgkmcnt(0)
    s_mul_i32 s45, s69, 2304
    buffer_load_dwordx3 v[132:134], v4, s[28:31], s45 offen
    buffer_load_dwordx3 v[136:138], v4, s[28:31], s45 offen offset:768
    buffer_load_dwordx3 v[140:142], v4, s[28:31], s45 offen offset:1536
    s_add_u32 s69, s69, 1
    s_cmp_eq_u32 s69, 9
    s_cselect_b32 s69, 0, s69
    s_cmp_gt_u32 s51, 2
    s_cbranch_scc1 K1_krd2
K1_kpw2:
    ds_read_b128 v[96:99], v2
    s_waitcnt lgkmcnt(0)
    v_min_u32 v6, v96, v97
    v_min3_u32 v6, v6, v98, v99
    s_nop 0
    v_readfirstlane_b32 s51, v6
    s_cmp_gt_u32 s51, 2
    s_cbranch_scc0 K1_kpw2
K1_krd2:
    s_waitcnt lgkmcnt(0)
    ds_read_b128 v[36:39], v8 offset:18944
    ds_read_b64_tr_b16 v[52:53], v12 offset:0
    ds_read_b64_tr_b16 v[54:55], v12 offset:160
    v_mfma_f32_32x32x16_bf16 v[16:31], v[116:119], v[100:103], v[16:31]
    ds_read_b128 v[40:43], v9 offset:18944
    ds_read_b64_tr_b16 v[56:57], v12 offset:640
    ds_read_b64_tr_b16 v[58:59], v12 offset:800
    v_mfma_f32_32x32x16_bf16 v[16:31], v[120:123], v[104:107], v[16:31]
    ds_read_b128 v[44:47], v10 offset:18944
    ds_read_b64_tr_b16 v[60:61], v12 offset:1280
    ds_read_b64_tr_b16 v[62:63], v12 offset:1440
    v_mfma_f32_32x32x16_bf16 v[16:31], v[124:127], v[108:111], v[16:31]
    ds_read_b128 v[48:51], v11 offset:18944
    ds_read_b64_tr_b16 v[64:65], v12 offset:1920
    ds_read_b64_tr_b16 v[66:67], v12 offset:2080
    v_mfma_f32_32x32x16_bf16 v[16:31], v[128:131], v[112:115], v[16:31]
    s_waitcnt vmcnt(12)
    ds_write2_b32 v92, v144, v145 offset0:0 offset1:1
    ds_write_b32 v92, v146 offset:8
    ds_write2_b32 v93, v148, v149 offset0:0 offset1:1
    ds_write_b32 v93, v150 offset:8
    ds_write2_b32 v94, v152, v153 offset0:0 offset1:1
    ds_write_b32 v94, v154 offset:8
    s_waitcnt lgkmcnt(0)
    s_mul_i32 s45, s69, 2304
    buffer_load_dwordx3 v[144:146], v4, s[28:31], s45 offen
    buffer_load_dwordx3 v[148:150], v4, s[28:31], s45 offen offset:768
    buffer_load_dwordx3 v[152:154], v4, s[28:31], s45 offen offset:1536
    s_add_u32 s69, s69, 1
    s_cmp_eq_u32 s69, 9
    s_cselect_b32 s69, 0, s69
    s_cmp_gt_u32 s51, 3
    s_cbranch_scc1 K1_krd3
K1_kpw3:
    ds_read_b128 v[96:99], v2
    s_waitcnt lgkmcnt(0)
    v_min_u32 v6, v96, v97
    v_min3_u32 v6, v6, v98, v99
    s_nop 0
    v_readfirstlane_b32 s51, v6
    s_cmp_gt_u32 s51, 3
    s_cbranch_scc0 K1_kpw3
K1_krd3:
    s_waitcnt lgkmcnt(0)
    ds_read_b128 v[100:103], v8 offset:28416
    ds_read_b64_tr_b16 v[116:117], v12 offset:0
    ds_read_b64_tr_b16 v[118:119], v12 offset:160
    v_mfma_f32_32x32x16_bf16 v[16:31], v[52:55], v[36:39], v[16:31]
    ds_read_b128 v[104:107], v9 offset:28416
    ds_read_b64_tr_b16 v[120:121], v12 offset:640
    ds_read_b64_tr_b16 v[122:123], v12 offset:800
    v_mfma_f32_32x32x16_bf16 v[16:31], v[56:59], v[40:43], v[16:31]
    ds_read_b128 v[108:111], v10 offset:28416
    ds_read_b64_tr_b16 v[124:125], v12 offset:1280
    ds_read_b64_tr_b16 v[126:127], v12 offset:1440
    v_mfma_f32_32x32x16_bf16 v[16:31], v[60:63], v[44:47], v[16:31]
    ds_read_b128 v[112:115], v11 offset:28416
    ds_read_b64_tr_b16 v[128:129], v12 offset:1920
    ds_read_b64_tr_b16 v[130:131], v12 offset:2080
    v_mfma_f32_32x32x16_bf16 v[16:31], v[64:67], v[48:51], v[16:31]
    s_waitcnt vmcnt(12)
    ds_write2_b32 v92, v156, v157 offset0:0 offset1:1
    ds_write_b32 v92, v158 offset:8
    ds_write2_b32 v93, v160, v161 offset0:0 offset1:1
    ds_write_b32 v93, v162 offset:8
    ds_write2_b32 v94, v164, v165 offset0:0 offset1:1
    ds_write_b32 v94, v166 offset:8
    s_cmp_gt_u32 s51, 4
    s_cbranch_scc1 K1_krd4
K1_kpw4:
    ds_read_b128 v[96:99], v2
    s_waitcnt lgkmcnt(0)
    v_min_u32 v6, v96, v97
    v_min3_u32 v6, v6, v98, v99
    s_nop 0
    v_readfirstlane_b32 s51, v6
    s_cmp_gt_u32 s51, 4
    s_cbranch_scc0 K1_kpw4
K1_krd4:
    s_waitcnt lgkmcnt(0)
    ds_read_b128 v[36:39], v8 offset:37888
    ds_read_b64_tr_b16 v[52:53], v12 offset:0
    ds_read_b64_tr_b16 v[54:55], v12 offset:160
    v_mfma_f32_32x32x16_bf16 v[16:31], v[116:119], v[100:103], v[16:31]
    ds_read_b128 v[40:43], v9 offset:37888
    ds_read_b64_tr_b16 v[56:57], v12 offset:640
    ds_read_b64_tr_b16 v[58:59], v12 offset:800
    v_mfma_f32_32x32x16_bf16 v[16:31], v[120:123], v[104:107], v[16:31]
    ds_read_b128 v[44:47], v10 offset:37888
    ds_read_b64_tr_b16 v[60:61], v12 offset:1280
    ds_read_b64_tr_b16 v[62:63], v12 offset:1440
    v_mfma_f32_32x32x16_bf16 v[16:31], v[124:127], v[108:111], v[16:31]
    ds_read_b128 v[48:51], v11 offset:37888
    ds_read_b64_tr_b16 v[64:65], v12 offset:1920
    ds_read_b64_tr_b16 v[66:67], v12 offset:2080
    v_mfma_f32_32x32x16_bf16 v[16:31], v[128:131], v[112:115], v[16:31]
    s_waitcnt vmcnt(9)
    ds_write2_b32 v92, v68, v69 offset0:0 offset1:1
    ds_write_b32 v92, v70 offset:8
    ds_write2_b32 v93, v72, v73 offset0:0 offset1:1
    ds_write_b32 v93, v74 offset:8
    ds_write2_b32 v94, v76, v77 offset0:0 offset1:1
    ds_write_b32 v94, v78 offset:8
    s_cmp_gt_u32 s51, 5
    s_cbranch_scc1 K1_krd5
K1_kpw5:
    ds_read_b128 v[96:99], v2
    s_waitcnt lgkmcnt(0)
    v_min_u32 v6, v96, v97
    v_min3_u32 v6, v6, v98, v99
    s_nop 0
    v_readfirstlane_b32 s51, v6
    s_cmp_gt_u32 s51, 5
    s_cbranch_scc0 K1_kpw5
K1_krd5:
    s_waitcnt lgkmcnt(0)
    ds_read_b128 v[100:103], v8 offset:47360
    ds_read_b64_tr_b16 v[116:117], v12 offset:0
    ds_read_b64_tr_b16 v[118:119], v12 offset:160
    v_mfma_f32_32x32x16_bf16 v[16:31], v[52:55], v[36:39], v[16:31]
    ds_read_b128 v[104:107], v9 offset:47360
    ds_read_b64_tr_b16 v[120:121], v12 offset:640
    ds_read_b64_tr_b16 v[122:123], v12 offset:800
    v_mfma_f32_32x32x16_bf16 v[16:31], v[56:59], v[40:43], v[16:31]
    ds_read_b128 v[108:111], v10 offset:47360
    ds_read_b64_tr_b16 v[124:125], v12 offset:1280
    ds_read_b64_tr_b16 v[126:127], v12 offset:1440
    v_mfma_f32_32x32x16_bf16 v[16:31], v[60:63], v[44:47], v[16:31]
    ds_read_b128 v[112:115], v11 offset:47360
    ds_read_b64_tr_b16 v[128:129], v12 offset:1920
    ds_read_b64_tr_b16 v[130:131], v12 offset:2080
    v_mfma_f32_32x32x16_bf16 v[16:31], v[64:67], v[48:51], v[16:31]
    s_waitcnt vmcnt(6)
    ds_write2_b32 v92, v80, v81 offset0:0 offset1:1
    ds_write_b32 v92, v82 offset:8
    ds_write2_b32 v93, v84, v85 offset0:0 offset1:1
    ds_write_b32 v93, v86 offset:8
    ds_write2_b32 v94, v88, v89 offset0:0 offset1:1
    ds_write_b32 v94, v90 offset:8
    s_cmp_gt_u32 s51, 6
    s_cbranch_scc1 K1_krd6
K1_kpw6:
    ds_read_b128 v[96:99], v2
    s_waitcnt lgkmcnt(0)
    v_min_u32 v6, v96, v97
    v_min3_u32 v6, v6, v98, v99
    s_nop 0
    v_readfirstlane_b32 s51, v6
    s_cmp_gt_u32 s51, 6
    s_cbranch_scc0 K1_kpw6
K1_krd6:
    v_add_u32 v8, 56832, v8
    v_add_u32 v9, 56832, v9
    v_add_u32 v10, 56832, v10
    v_add_u32 v11, 56832, v11
    s_waitcnt lgkmcnt(0)
    ds_read_b128 v[36:39], v8 offset:0
    ds_read_b64_tr_b16 v[52:53], v12 offset:0
    ds_read_b64_tr_b16 v[54:55], v12 offset:160
    v_mfma_f32_32x32x16_bf16 v[16:31], v[116:119], v[100:103], v[16:31]
    ds_read_b128 v[40:43], v9 offset:0
    ds_read_b64_tr_b16 v[56:57], v12 offset:640
    ds_read_b64_tr_b16 v[58:59], v12 offset:800
    v_mfma_f32_32x32x16_bf16 v[16:31], v[120:123], v[104:107], v[16:31]
    ds_read_b128 v[44:47], v10 offset:0
    ds_read_b64_tr_b16 v[60:61], v12 offset:1280
    ds_read_b64_tr_b16 v[62:63], v12 offset:1440
    v_mfma_f32_32x32x16_bf16 v[16:31], v[124:127], v[108:111], v[16:31]
    ds_read_b128 v[48:51], v11 offset:0
    ds_read_b64_tr_b16 v[64:65], v12 offset:1920
    ds_read_b64_tr_b16 v[66:67], v12 offset:2080
    v_mfma_f32_32x32x16_bf16 v[16:31], v[128:131], v[112:115], v[16:31]
    s_waitcnt vmcnt(3)
    ds_write2_b32 v92, v132, v133 offset0:0 offset1:1
    ds_write_b32 v92, v134 offset:8
    ds_write2_b32 v93, v136, v137 offset0:0 offset1:1
    ds_write_b32 v93, v138 offset:8
    ds_write2_b32 v94, v140, v141 offset0:0 offset1:1
    ds_write_b32 v94, v142 offset:8
    s_cmp_gt_u32 s51, 7
    s_cbranch_scc1 K1_krd7
K1_kpw7:
    ds_read_b128 v[96:99], v2
    s_waitcnt lgkmcnt(0)
    v_min_u32 v6, v96, v97
    v_min3_u32 v6, v6, v98, v99
    s_nop 0
    v_readfirstlane_b32 s51, v6
    s_cmp_gt_u32 s51, 7
    s_cbranch_scc0 K1_kpw7
K1_krd7:
    s_waitcnt lgkmcnt(0)
    ds_read_b128 v[100:103], v8 offset:9472
    ds_read_b64_tr_b16 v[116:117], v12 offset:0
    ds_read_b64_tr_b16 v[118:119], v12 offset:160
    v_mfma_f32_32x32x16_bf16 v[16:31], v[52:55], v[36:39], v[16:31]
    ds_read_b128 v[104:107], v9 offset:9472
    ds_read_b64_tr_b16 v[120:121], v12 offset:640
    ds_read_b64_tr_b16 v[122:123], v12 offset:800
    v_mfma_f32_32x32x16_bf16 v[16:31], v[56:59], v[40:43], v[16:31]
    ds_read_b128 v[108:111], v10 offset:9472
    ds_read_b64_tr_b16 v[124:125], v12 offset:1280
    ds_read_b64_tr_b16 v[126:127], v12 offset:1440
    v_mfma_f32_32x32x16_bf16 v[16:31], v[60:63], v[44:47], v[16:31]
    ds_read_b128 v[112:115], v11 offset:9472
    ds_read_b64_tr_b16 v[128:129], v12 offset:1920
    ds_read_b64_tr_b16 v[130:131], v12 offset:2080
    v_mfma_f32_32x32x16_bf16 v[16:31], v[64:67], v[48:51], v[16:31]
    s_waitcnt vmcnt(0)
    ds_write2_b32 v92, v144, v145 offset0:0 offset1:1
    ds_write_b32 v92, v146 offset:8
    ds_write2_b32 v93, v148, v149 offset0:0 offset1:1
    ds_write_b32 v93, v150 offset:8
    ds_write2_b32 v94, v152, v153 offset0:0 offset1:1
    ds_write_b32 v94, v154 offset:8
    s_cmp_gt_u32 s51, 8
    s_cbranch_scc1 K1_krd8
K1_kpw8:
    ds_read_b128 v[96:99], v2
    s_waitcnt lgkmcnt(0)
    v_min_u32 v6, v96, v97
    v_min3_u32 v6, v6, v98, v99
    s_nop 0
    v_readfirstlane_b32 s51, v6
    s_cmp_gt_u32 s51, 8
    s_cbranch_scc0 K1_kpw8
K1_krd8:
    s_waitcnt lgkmcnt(0)
    ds_read_b128 v[36:39], v8 offset:18944
    ds_read_b64_tr_b16 v[52:53], v12 offset:0
    ds_read_b64_tr_b16 v[54:55], v12 offset:160
    v_mfma_f32_32x32x16_bf16 v[16:31], v[116:119], v[100:103], v[16:31]
    ds_read_b128 v[40:43], v9 offset:18944
    ds_read_b64_tr_b16 v[56:57], v12 offset:640
    ds_read_b64_tr_b16 v[58:59], v12 offset:800
    v_mfma_f32_32x32x16_bf16 v[16:31], v[120:123], v[104:107], v[16:31]
    ds_read_b128 v[44:47], v10 offset:18944
    ds_read_b64_tr_b16 v[60:61], v12 offset:1280
    ds_read_b64_tr_b16 v[62:63], v12 offset:1440
    v_mfma_f32_32x32x16_bf16 v[16:31], v[124:127], v[108:111], v[16:31]
    ds_read_b128 v[48:51], v11 offset:18944
    ds_read_b64_tr_b16 v[64:65], v12 offset:1920
    ds_read_b64_tr_b16 v[66:67], v12 offset:2080
    v_mfma_f32_32x32x16_bf16 v[16:31], v[128:131], v[112:115], v[16:31]
    s_waitcnt lgkmcnt(9)
    v_mfma_f32_32x32x16_bf16 v[16:31], v[52:55], v[36:39], v[16:31]
    s_waitcnt lgkmcnt(6)
    v_mfma_f32_32x32x16_bf16 v[16:31], v[56:59], v[40:43], v[16:31]
    s_waitcnt lgkmcnt(3)
    v_mfma_f32_32x32x16_bf16 v[16:31], v[60:63], v[44:47], v[16:31]
    s_waitcnt lgkmcnt(0)
    v_mfma_f32_32x32x16_bf16 v[16:31], v[64:67], v[48:51], v[16:31]
    s_cmp_eq_u32 s49, 1
    s_cselect_b32 s46, 0x5f800000, 1.0
    v_add_u32 v96, s47, v34
    v_lshrrev_b32 v4, 5, v96
    v_mul_u32_u24 v97, 2368, v4
    v_lshrrev_b32 v4, 8, v96
    v_lshlrev_b32 v4, 9, v4
    v_add_u32 v97, v97, v4
    v_mov_b32 v5, 0x40000000
    v_cmp_lt_u32 vcc, 73, v34
    s_nop 1
    v_cndmask_b32 v97, v97, v5, vcc
    v_cmp_gt_u32 vcc, s58, v34
    s_nop 1
    v_cndmask_b32 v97, v97, v5, vcc
    v_and_b32 v96, 31, v96
    s_mov_b32 s45, 2359296
    v_mul_f32 v16, s46, v16
    v_mul_f32 v17, s46, v17
    v_mul_f32 v18, s46, v18
    v_mul_f32 v19, s46, v19
    v_mul_f32 v20, s46, v20
    v_mul_f32 v21, s46, v21
    v_mul_f32 v22, s46, v22
    v_mul_f32 v23, s46, v23
    v_mul_f32 v24, s46, v24
    v_mul_f32 v25, s46, v25
    v_mul_f32 v26, s46, v26
    v_mul_f32 v27, s46, v27
    v_cvt_pk_bf16_f32 v68, v16, v17
    v_cvt_pk_bf16_f32 v69, v18, v19
    v_cvt_pk_bf16_f32 v70, v20, v21
    v_cvt_pk_bf16_f32 v71, v22, v23
    v_cvt_pk_bf16_f32 v72, v24, v25
    v_cvt_pk_bf16_f32 v73, v26, v27
    s_cmp_eq_u32 s49, 1
    s_cbranch_scc1 K1_vout
    v_lshlrev_b32 v4, 4, v96
    v_lshlrev_b32 v5, 9, v35
    v_add_u32 v4, v4, v5
    v_add_u32 v4, v4, v97
    v_lshlrev_b32 v5, 2, v96
    v_add_u32 v5, v5, v97
    v_permlane32_swap_b32 v68, v70
    v_permlane32_swap_b32 v69, v71
    buffer_store_dwordx4 v[68:71], v4, s[24:27], s45 offen
    s_mov_b32 exec_hi, 0
    buffer_store_dword v72, v5, s[24:27], s45 offen offset:1024
    s_branch K1_end
K1_vout:
    v_lshrrev_b32 v5, 4, v96
    v_mul_u32_u24 v5, 608, v5
    v_bfe_u32 v6, v96, 2, 1
    v_mul_u32_u24 v6, 304, v6
    v_add_u32 v5, v5, v6
    v_and_b32 v6, 8, v96
    v_add_u32 v5, v5, v6
    v_and_b32 v6, 3, v96
    v_lshlrev_b32 v6, 1, v6
    v_add_u32 v5, v5, v6
    v_add_u32 v5, v5, v97
    v_lshlrev_b32 v6, 6, v35
    v_add_u32 v6, v5, v6
    v_mul_u32_u24 v7, 288, v35
    v_add_u32 v7, v5, v7
    v_mov_b32 v4, 0x5f80
    buffer_store_short v68, v7, s[24:27], s45 offen offset:1152
    buffer_store_short_d16_hi v68, v6, s[24:27], s45 offen offset:1168
    buffer_store_short v69, v6, s[24:27], s45 offen offset:1184
    buffer_store_short_d16_hi v69, v6, s[24:27], s45 offen offset:1200
    buffer_store_short v70, v6, s[24:27], s45 offen offset:1280
    buffer_store_short_d16_hi v70, v6, s[24:27], s45 offen offset:1296
    buffer_store_short v71, v6, s[24:27], s45 offen offset:1312
    buffer_store_short_d16_hi v71, v6, s[24:27], s45 offen offset:1328
    s_mov_b32 exec_hi, 0
    buffer_store_short v72, v5, s[24:27], s45 offen offset:1408
    buffer_store_short_d16_hi v72, v5, s[24:27], s45 offen offset:1424
    buffer_store_short v4, v5, s[24:27], s45 offen offset:1216
    s_branch K1_end
K1_spare:
    s_cmp_lg_u32 s43, 252
    s_cbranch_scc1 K1_end
    s_mov_b32 s51, 512
    s_cmp_eq_u32 s40, 8
    s_cbranch_scc1 K1_xf2
    s_cmp_ge_u32 s40, 6
    s_cbranch_scc1 K1_end
    v_lshlrev_b32 v8, 4, v1
    v_mov_b32 v12, 0
    v_mov_b32 v13, 0
    v_mov_b32 v14, 0
    v_mov_b32 v15, 0
    s_lshl_b32 s45, s40, 10
    s_add_u32 s45, s45, 8585216
    buffer_store_dwordx4 v[12:15], v8, s[24:27], s45 offen
    s_branch K1_end
K1_xf:
    s_cmp_eq_u32 s40, 11
    s_cbranch_scc1 K1_rep
    s_lshr_b32 s45, s2, 5
    s_lshl_b32 s45, s45, 3
    s_and_b32 s46, s2, 7
    s_add_u32 s45, s45, s46
    s_lshl_b32 s45, s45, 3
    s_lshr_b32 s46, s2, 2
    s_and_b32 s46, s46, 6
    s_add_u32 s51, s45, s46
    s_add_u32 s51, s51, s40
    s_sub_u32 s51, s51, 9
K1_xf2:
    s_mov_b32 s59, s51
    s_lshl_b32 s45, s51, 1
    s_sub_u32 s46, s45, 511
    s_cmp_lt_u32 s51, 256
    s_cselect_b32 s45, s45, s46
    s_cmp_lt_u32 s51, 512
    s_cselect_b32 s51, s45, s51
    s_setprio 0
    s_mov_b32 s32, s12
    s_mov_b32 s33, s13
    s_mov_b32 s34, 0x240000
    s_mov_b32 s35, 0x00020000
    s_mul_i32 s52, s51, 1152
    s_sub_u32 s53, 2359296, s52
    s_sub_u32 s54, 1179648, s52
    s_add_u32 s55, 1179648, s52
    s_cmp_eq_u32 s51, 0
    s_cselect_b32 s53, 0x40000000, s53
    s_cselect_b32 s54, 0x40000000, s54
    s_cmp_ge_u32 s51, 512
    s_cselect_b32 s54, 0x40000000, s54
    s_cselect_b32 s55, 0x40000000, s55
    s_cmp_ge_u32 s51, 513
    s_cselect_b32 s52, 0x40000000, s52
    s_cselect_b32 s53, 0x40000000, s53
    v_mov_b32 v7, 0x40000000
    v_lshlrev_b32 v8, 4, v1
    v_sub_u32 v9, 1136, v8
    v_sub_u32 v10, 1152, v8
    v_cmp_lt_u32 vcc, 36, v1
    s_nop 1
    v_cndmask_b32 v8, v8, v7, vcc
    v_cmp_lt_u32 vcc, 35, v1
    s_nop 1
    v_cndmask_b32 v9, v9, v7, vcc
    v_cndmask_b32 v10, v10, v7, vcc
    v_cmp_eq_u32 vcc, 0, v1
    s_nop 1
    v_cndmask_b32 v10, v10, v7, vcc
    buffer_load_dwordx4 v[16:19], v8, s[32:35], s52 offen
    buffer_load_dwordx4 v[32:35], v9, s[32:35], s52 offen
    buffer_load_ushort v48, v10, s[32:35], s52 offen
    buffer_load_dwordx4 v[20:23], v8, s[32:35], s53 offen
    buffer_load_dwordx4 v[36:39], v9, s[32:35], s53 offen
    buffer_load_ushort v49, v10, s[32:35], s53 offen
    buffer_load_dwordx4 v[24:27], v8, s[32:35], s54 offen
    buffer_load_dwordx4 v[40:43], v9, s[32:35], s54 offen
    buffer_load_ushort v50, v10, s[32:35], s54 offen
    buffer_load_dwordx4 v[28:31], v8, s[32:35], s55 offen
    buffer_load_dwordx4 v[44:47], v9, s[32:35], s55 offen
    buffer_load_ushort v51, v10, s[32:35], s55 offen
K1_xf3:
    s_waitcnt vmcnt(0)
    v_lshlrev_b32 v52, 16, v16
    v_lshlrev_b32 v53, 16, v48
    v_add_f32 v56, v52, v53
    v_sub_f32 v88, v52, v53
    v_and_b32 v52, 0xffff0000, v16
    v_and_b32 v53, 0xffff0000, v35
    v_add_f32 v57, v52, v53
    v_sub_f32 v89, v52, v53
    v_lshlrev_b32 v52, 16, v17
    v_lshlrev_b32 v53, 16, v35
    v_add_f32 v58, v52, v53
    v_sub_f32 v90, v52, v53
    v_and_b32 v52, 0xffff0000, v17
    v_and_b32 v53, 0xffff0000, v34
    v_add_f32 v59, v52, v53
    v_sub_f32 v91, v52, v53
    v_lshlrev_b32 v52, 16, v18
    v_lshlrev_b32 v53, 16, v34
    v_add_f32 v60, v52, v53
    v_sub_f32 v92, v52, v53
    v_and_b32 v52, 0xffff0000, v18
    v_and_b32 v53, 0xffff0000, v33
    v_add_f32 v61, v52, v53
    v_sub_f32 v93, v52, v53
    v_lshlrev_b32 v52, 16, v19
    v_lshlrev_b32 v53, 16, v33
    v_add_f32 v62, v52, v53
    v_sub_f32 v94, v52, v53
    v_and_b32 v52, 0xffff0000, v19
    v_and_b32 v53, 0xffff0000, v32
    v_add_f32 v63, v52, v53
    v_sub_f32 v95, v52, v53
    v_lshlrev_b32 v52, 16, v20
    v_lshlrev_b32 v53, 16, v49
    v_add_f32 v64, v52, v53
    v_sub_f32 v96, v52, v53
    v_and_b32 v52, 0xffff0000, v20
    v_and_b32 v53, 0xffff0000, v39
    v_add_f32 v65, v52, v53
    v_sub_f32 v97, v52, v53
    v_lshlrev_b32 v52, 16, v21
    v_lshlrev_b32 v53, 16, v39
    v_add_f32 v66, v52, v53
    v_sub_f32 v98, v52, v53
    v_and_b32 v52, 0xffff0000, v21
    v_and_b32 v53, 0xffff0000, v38
    v_add_f32 v67, v52, v53
    v_sub_f32 v99, v52, v53
    v_lshlrev_b32 v52, 16, v22
    v_lshlrev_b32 v53, 16, v38
    v_add_f32 v68, v52, v53
    v_sub_f32 v100, v52, v53
    v_and_b32 v52, 0xffff0000, v22
    v_and_b32 v53, 0xffff0000, v37
    v_add_f32 v69, v52, v53
    v_sub_f32 v101, v52, v53
    v_lshlrev_b32 v52, 16, v23
    v_lshlrev_b32 v53, 16, v37
    v_add_f32 v70, v52, v53
    v_sub_f32 v102, v52, v53
    v_and_b32 v52, 0xffff0000, v23
    v_and_b32 v53, 0xffff0000, v36
    v_add_f32 v71, v52, v53
    v_sub_f32 v103, v52, v53
    v_lshlrev_b32 v52, 16, v24
    v_lshlrev_b32 v53, 16, v50
    v_add_f32 v72, v52, v53
    v_sub_f32 v104, v52, v53
    v_and_b32 v52, 0xffff0000, v24
    v_and_b32 v53, 0xffff0000, v43
    v_add_f32 v73, v52, v53
    v_sub_f32 v105, v52, v53
    v_lshlrev_b32 v52, 16, v25
    v_lshlrev_b32 v53, 16, v43
    v_add_f32 v74, v52, v53
    v_sub_f32 v106, v52, v53
    v_and_b32 v52, 0xffff0000, v25
    v_and_b32 v53, 0xffff0000, v42
    v_add_f32 v75, v52, v53
    v_sub_f32 v107, v52, v53
    v_lshlrev_b32 v52, 16, v26
    v_lshlrev_b32 v53, 16, v42
    v_add_f32 v76, v52, v53
    v_sub_f32 v108, v52, v53
    v_and_b32 v52, 0xffff0000, v26
    v_and_b32 v53, 0xffff0000, v41
    v_add_f32 v77, v52, v53
    v_sub_f32 v109, v52, v53
    v_lshlrev_b32 v52, 16, v27
    v_lshlrev_b32 v53, 16, v41
    v_add_f32 v78, v52, v53
    v_sub_f32 v110, v52, v53
    v_and_b32 v52, 0xffff0000, v27
    v_and_b32 v53, 0xffff0000, v40
    v_add_f32 v79, v52, v53
    v_sub_f32 v111, v52, v53
    v_lshlrev_b32 v52, 16, v28
    v_lshlrev_b32 v53, 16, v51
    v_add_f32 v80, v52, v53
    v_sub_f32 v112, v52, v53
    v_and_b32 v52, 0xffff0000, v28
    v_and_b32 v53, 0xffff0000, v47
    v_add_f32 v81, v52, v53
    v_sub_f32 v113, v52, v53
    v_lshlrev_b32 v52, 16, v29
    v_lshlrev_b32 v53, 16, v47
    v_add_f32 v82, v52, v53
    v_sub_f32 v114, v52, v53
    v_and_b32 v52, 0xffff0000, v29
    v_and_b32 v53, 0xffff0000, v46
    v_add_f32 v83, v52, v53
    v_sub_f32 v115, v52, v53
    v_lshlrev_b32 v52, 16, v30
    v_lshlrev_b32 v53, 16, v46
    v_add_f32 v84, v52, v53
    v_sub_f32 v116, v52, v53
    v_and_b32 v52, 0xffff0000, v30
    v_and_b32 v53, 0xffff0000, v45
    v_add_f32 v85, v52, v53
    v_sub_f32 v117, v52, v53
    v_lshlrev_b32 v52, 16, v31
    v_lshlrev_b32 v53, 16, v45
    v_add_f32 v86, v52, v53
    v_sub_f32 v118, v52, v53
    v_and_b32 v52, 0xffff0000, v31
    v_and_b32 v53, 0xffff0000, v44
    v_add_f32 v87, v52, v53
    v_sub_f32 v119, v52, v53
    v_add_f32 v52, v56, v64
    v_add_f32 v53, v72, v80
    v_add_f32 v120, v52, v53
    v_sub_f32 v128, v52, v53
    v_sub_f32 v52, v88, v96
    v_sub_f32 v53, v112, v104
    v_add_f32 v136, v52, v53
    v_sub_f32 v144, v52, v53
    v_add_f32 v52, v57, v65
    v_add_f32 v53, v73, v81
    v_add_f32 v121, v52, v53
    v_sub_f32 v129, v52, v53
    v_sub_f32 v52, v89, v97
    v_sub_f32 v53, v113, v105
    v_add_f32 v137, v52, v53
    v_sub_f32 v145, v52, v53
    v_add_f32 v52, v58, v66
    v_add_f32 v53, v74, v82
    v_add_f32 v122, v52, v53
    v_sub_f32 v130, v52, v53
    v_sub_f32 v52, v90, v98
    v_sub_f32 v53, v114, v106
    v_add_f32 v138, v52, v53
    v_sub_f32 v146, v52, v53
    v_add_f32 v52, v59, v67
    v_add_f32 v53, v75, v83
    v_add_f32 v123, v52, v53
    v_sub_f32 v131, v52, v53
    v_sub_f32 v52, v91, v99
    v_sub_f32 v53, v115, v107
    v_add_f32 v139, v52, v53
    v_sub_f32 v147, v52, v53
    v_add_f32 v52, v60, v68
    v_add_f32 v53, v76, v84
    v_add_f32 v124, v52, v53
    v_sub_f32 v132, v52, v53
    v_sub_f32 v52, v92, v100
    v_sub_f32 v53, v116, v108
    v_add_f32 v140, v52, v53
    v_sub_f32 v148, v52, v53
    v_add_f32 v52, v61, v69
    v_add_f32 v53, v77, v85
    v_add_f32 v125, v52, v53
    v_sub_f32 v133, v52, v53
    v_sub_f32 v52, v93, v101
    v_sub_f32 v53, v117, v109
    v_add_f32 v141, v52, v53
    v_sub_f32 v149, v52, v53
    v_add_f32 v52, v62, v70
    v_add_f32 v53, v78, v86
    v_add_f32 v126, v52, v53
    v_sub_f32 v134, v52, v53
    v_sub_f32 v52, v94, v102
    v_sub_f32 v53, v118, v110
    v_add_f32 v142, v52, v53
    v_sub_f32 v150, v52, v53
    v_add_f32 v52, v63, v71
    v_add_f32 v53, v79, v87
    v_add_f32 v127, v52, v53
    v_sub_f32 v135, v52, v53
    v_sub_f32 v52, v95, v103
    v_sub_f32 v53, v119, v111
    v_add_f32 v143, v52, v53
    v_sub_f32 v151, v52, v53
    v_cmp_eq_u32 vcc, 36, v1
    v_mov_b32 v52, 0xffff
    v_mov_b32 v53, 0
    v_cndmask_b32 v11, -1, v52, vcc
    v_cndmask_b32 v12, -1, v53, vcc
    v_cvt_pk_bf16_f32 v16, v120, v122
    v_cvt_pk_bf16_f32 v17, v124, v126
    v_cvt_pk_bf16_f32 v18, v121, v123
    v_cvt_pk_bf16_f32 v19, v125, v127
    v_cvt_pk_bf16_f32 v20, v128, v130
    v_cvt_pk_bf16_f32 v21, v132, v134
    v_cvt_pk_bf16_f32 v22, v129, v131
    v_cvt_pk_bf16_f32 v23, v133, v135
    v_cvt_pk_bf16_f32 v24, v136, v138
    v_cvt_pk_bf16_f32 v25, v140, v142
    v_cvt_pk_bf16_f32 v26, v137, v139
    v_cvt_pk_bf16_f32 v27, v141, v143
    v_cvt_pk_bf16_f32 v28, v144, v146
    v_cvt_pk_bf16_f32 v29, v148, v150
    v_cvt_pk_bf16_f32 v30, v145, v147
    v_cvt_pk_bf16_f32 v31, v149, v151
    v_and_b32 v16, v16, v11
    v_and_b32 v17, v17, v12
    v_and_b32 v18, v18, v12
    v_and_b32 v19, v19, v12
    v_and_b32 v20, v20, v11
    v_and_b32 v21, v21, v12
    v_and_b32 v22, v22, v12
    v_and_b32 v23, v23, v12
    v_and_b32 v24, v24, v11
    v_and_b32 v25, v25, v12
    v_and_b32 v26, v26, v12
    v_and_b32 v27, v27, v12
    v_and_b32 v28, v28, v11
    v_and_b32 v29, v29, v12
    v_and_b32 v30, v30, v12
    v_and_b32 v31, v31, v12
    s_cmp_ge_u32 s51, 544
    s_cbranch_scc1 K1_end
    s_lshr_b32 s45, s59, 5
    s_mul_i32 s45, s45, 19456
    s_and_b32 s46, s59, 31
    s_lshl_b32 s46, s46, 4
    s_add_u32 s45, s45, s46
    s_add_u32 s45, s45, 4980736
    v_lshrrev_b32 v4, 1, v1
    v_lshlrev_b32 v4, 9, v4
    v_and_b32 v5, 1, v1
    v_lshlrev_b32 v5, 3, v5
    v_add_u32 v4, v4, v5
    v_add_u32 v5, 10240, v4
    v_mov_b32 v6, 0x40000000
    v_cmp_lt_u32 vcc, 35, v1
    s_nop 1
    v_cndmask_b32 v5, v5, v6, vcc
    s_mov_b32 exec_hi, 0xff
    buffer_store_dwordx2 v[16:17], v4, s[24:27], s45 offen
    buffer_store_dwordx2 v[18:19], v5, s[24:27], s45 offen
    s_add_u32 s45, s45, 330752
    buffer_store_dwordx2 v[20:21], v4, s[24:27], s45 offen
    buffer_store_dwordx2 v[22:23], v5, s[24:27], s45 offen
    s_add_u32 s45, s45, 330752
    buffer_store_dwordx2 v[24:25], v4, s[24:27], s45 offen
    buffer_store_dwordx2 v[26:27], v5, s[24:27], s45 offen
    s_add_u32 s45, s45, 330752
    buffer_store_dwordx2 v[28:29], v4, s[24:27], s45 offen
    buffer_store_dwordx2 v[30:31], v5, s[24:27], s45 offen
    s_branch K1_end
K1_rep:
    s_mov_b32 s60, s88
    s_mov_b32 s61, s89
    s_mov_b32 s62, 0xa2000
    s_mov_b32 s63, 0x00020000
    v_lshlrev_b32 v10, 4, v1
    s_mul_i32 s45, s43, 21846
    s_lshr_b32 s45, s45, 18
    s_mul_i32 s46, s45, 12
    s_sub_u32 s46, s43, s46
    s_mul_i32 s67, s45, 36864
    s_mul_i32 s46, s46, 96
    s_add_u32 s67, s67, s46
    s_mul_i32 s68, s43, 3072
    s_add_u32 s68, s68, 7733248
    s_cmp_ge_u32 s43, 216
    s_cselect_b32 s67, 0x40000000, s67
    s_cselect_b32 s68, 0x40000000, s68
    v_lshrrev_b32 v9, 4, v1
    v_mul_u32_u24 v9, 9216, v9
    v_and_b32 v11, 15, v1
    v_lshlrev_b32 v11, 1, v11
    v_add_u32 v9, v9, v11
    v_add_u32 v11, 4608, v9
    s_mul_i32 s46, s43, 6554
    s_lshr_b32 s46, s46, 16
    s_mul_i32 s45, s46, 10
    s_sub_u32 s45, s43, s45
    s_cmp_lt_u32 s46, 8
    s_cselect_b32 s28, s96, s98
    s_cselect_b32 s29, s97, s99
    s_mov_b32 s30, 663552
    s_lshl_b32 s51, s45, 6
    s_mul_i32 s52, s46, 19
    s_add_u32 s52, s52, s45
    s_mul_i32 s52, s52, 608
    s_add_u32 s52, s52, 9175040
    s_add_u32 s53, s52, 6080
    s_cmp_eq_u32 s45, 9
    s_cselect_b32 s53, 0x40000000, s53
    s_cmp_ge_u32 s43, 160
    s_cselect_b32 s51, 0x40000000, s51
    s_cselect_b32 s52, 0x40000000, s52
    s_cselect_b32 s53, 0x40000000, s53
    s_and_b32 s46, s46, 7
    s_mul_i32 s46, s46, 18
    v_and_b32 v12, 31, v1
    v_lshrrev_b32 v13, 5, v1
    v_lshlrev_b32 v14, 4, v12
    v_mul_u32_u24 v15, 304, v13
    v_add_u32 v14, v14, v15
    v_add_u32 v15, s46, v12
    v_mul_u32_u24 v15, 1152, v15
    v_lshlrev_b32 v13, 5, v13
    v_add_u32 v15, v15, v13
    v_mov_b32 v13, 0x40000000
    v_cmp_lt_u32 vcc, 18, v12
    s_nop 1
    v_cndmask_b32 v14, v14, v13, vcc
    v_cndmask_b32 v15, v15, v13, vcc
    s_mov_b32 s31, 0x00020000
    buffer_load_dwordx4 v[88:91], v15, s[28:31], s51 offen offset:0
    buffer_load_dwordx4 v[92:95], v15, s[28:31], s51 offen offset:16
    buffer_load_ushort v64, v9, s[60:63], s67 offen offset:0
    buffer_load_ushort v65, v9, s[60:63], s67 offen offset:1152
    buffer_load_ushort v66, v9, s[60:63], s67 offen offset:2304
    buffer_load_ushort v67, v9, s[60:63], s67 offen offset:3456
    buffer_load_ushort v68, v11, s[60:63], s67 offen offset:0
    buffer_load_ushort v69, v11, s[60:63], s67 offen offset:1152
    buffer_load_ushort v70, v11, s[60:63], s67 offen offset:2304
    buffer_load_ushort v71, v11, s[60:63], s67 offen offset:3456
    buffer_load_ushort v72, v9, s[60:63], s67 offen offset:32
    buffer_load_ushort v73, v9, s[60:63], s67 offen offset:1184
    buffer_load_ushort v74, v9, s[60:63], s67 offen offset:2336
    buffer_load_ushort v75, v9, s[60:63], s67 offen offset:3488
    buffer_load_ushort v76, v11, s[60:63], s67 offen offset:32
    buffer_load_ushort v77, v11, s[60:63], s67 offen offset:1184
    buffer_load_ushort v78, v11, s[60:63], s67 offen offset:2336
    buffer_load_ushort v79, v11, s[60:63], s67 offen offset:3488
    buffer_load_ushort v80, v9, s[60:63], s67 offen offset:64
    buffer_load_ushort v81, v9, s[60:63], s67 offen offset:1216
    buffer_load_ushort v82, v9, s[60:63], s67 offen offset:2368
    buffer_load_ushort v83, v9, s[60:63], s67 offen offset:3520
    buffer_load_ushort v84, v11, s[60:63], s67 offen offset:64
    buffer_load_ushort v85, v11, s[60:63], s67 offen offset:1216
    buffer_load_ushort v86, v11, s[60:63], s67 offen offset:2368
    buffer_load_ushort v87, v11, s[60:63], s67 offen offset:3520
    s_waitcnt vmcnt(0)
    s_mov_b32 s64, 0x05040100
    s_mov_b32 s65, 0x07060302
    v_perm_b32 v96, v89, v88, s64
    v_perm_b32 v100, v89, v88, s65
    v_perm_b32 v97, v91, v90, s64
    v_perm_b32 v101, v91, v90, s65
    v_perm_b32 v98, v93, v92, s64
    v_perm_b32 v102, v93, v92, s65
    v_perm_b32 v99, v95, v94, s64
    v_perm_b32 v103, v95, v94, s65
    buffer_store_dwordx4 v[96:99], v14, s[24:27], s52 offen sc1
    buffer_store_dwordx4 v[100:103], v14, s[24:27], s53 offen sc1
    v_lshl_or_b32 v52, v65, 16, v64
    v_lshl_or_b32 v53, v67, 16, v66
    v_lshl_or_b32 v54, v69, 16, v68
    v_lshl_or_b32 v55, v71, 16, v70
    buffer_store_dwordx4 v[52:55], v10, s[24:27], s68 offen offset:0 sc1
    v_lshl_or_b32 v56, v73, 16, v72
    v_lshl_or_b32 v57, v75, 16, v74
    v_lshl_or_b32 v58, v77, 16, v76
    v_lshl_or_b32 v59, v79, 16, v78
    buffer_store_dwordx4 v[56:59], v10, s[24:27], s68 offen offset:1024 sc1
    v_lshl_or_b32 v60, v81, 16, v80
    v_lshl_or_b32 v61, v83, 16, v82
    v_lshl_or_b32 v62, v85, 16, v84
    v_lshl_or_b32 v63, v87, 16, v86
    buffer_store_dwordx4 v[60:63], v10, s[24:27], s68 offen offset:2048 sc1
K1_end:
K1_exit:
    s_endpgm
.globl k2_kernel
.p2align 8
.type k2_kernel,@function
k2_kernel:
    s_cmp_ge_u32 s2, 256
    s_cbranch_scc1 K2_exit
    s_load_dwordx2 s[14:15], s[0:1], 96
    s_load_dwordx4 s[8:11], s[0:1], 48
    s_load_dwordx4 s[92:95], s[0:1], 80
    v_and_b32 v1, 63, v0
    v_lshrrev_b32 v2, 6, v0
    v_lshlrev_b32 v3, 4, v1
    v_readfirstlane_b32 s40, v2
    s_lshr_b32 s69, s2, 3
    s_and_b32 s69, s69, 7
    s_mov_b32 s58, -1
    s_mov_b32 s59, 0
    s_and_b32 s23, s2, 7
    s_lshl_b32 s23, s23, 5
    s_lshr_b32 s51, s2, 3
    s_add_u32 s23, s23, s51
    s_mul_i32 s51, s23, 9216
    v_lshlrev_b32 v4, 2, v1
    v_add_u32 v4, 110336, v4
    v_mov_b32 v5, 0
    ds_write_b32 v4, v5
    v_and_b32 v4, 31, v1
    v_mul_u32_u24 v4, 2560, v4
    ds_write_b32 v4, v5 offset:18444
    s_waitcnt lgkmcnt(0)
    s_barrier
    s_mov_b32 s24, s14
    s_mov_b32 s25, s15
    s_mov_b32 s26, 0x6000000
    s_mov_b32 s27, 0x00020000
    s_cmp_ge_u32 s40, 8
    s_cbranch_scc1 K2_helper
    v_and_b32 v134, 31, v1
    v_lshrrev_b32 v128, 5, v1
    v_and_b32 v129, 7, v1
    v_mul_u32_u24 v129, 1152, v129
    v_lshrrev_b32 v130, 3, v134
    v_mul_u32_u24 v130, 36, v130
    v_add_u32 v137, v129, v130
    v_lshlrev_b32 v130, 4, v128
    v_add_u32 v136, v137, v130
    v_lshlrev_b32 v2, 2, v134
    v_mov_b32 v149, 0
    s_sub_u32 s64, s40, 4
    s_cmp_lt_u32 s40, 4
    s_cselect_b32 s64, 0, s64
    s_mul_i32 s45, s64, 288
    s_add_u32 s45, s45, s51
    s_mul_i32 s46, s69, 2368
    s_add_u32 s46, s46, 2359296
    buffer_load_dwordx4 v[160:163], v136, s[24:27], s45 offen offset:0
    buffer_load_dword v150, v137, s[24:27], s45 offen offset:32
    buffer_load_dwordx4 v[144:147], v3, s[24:27], s46 offen
    buffer_load_dword v148, v2, s[24:27], s46 offen offset:1024
    s_mul_i32 s54, s40, 19456
    s_add_u32 s54, s54, 2359296
    s_mov_b32 s60, 0x7ffff
    s_mov_b32 s61, 0x7ffff
    v_mov_b32 v129, v134
    v_cmp_eq_u32 vcc, 4, v134
    s_nop 1
    v_cndmask_b32 v129, v129, 18, vcc
    v_cmp_eq_u32 vcc, 18, v134
    s_nop 1
    v_cndmask_b32 v129, v129, 4, vcc
    v_lshlrev_b32 v129, 4, v129
    v_mul_u32_u24 v128, 304, v128
    v_add_u32 v4, v128, v129
    s_mul_i32 s63, s40, 2560
    s_add_u32 s63, s63, 16384
    v_add_u32 v6, s63, v3
    v_mov_b32 v7, 110384
    v_add_u32 v5, 2048, v3
    s_mov_b32 s52, 0
    s_mov_b32 s65, 0
    v_mov_b32 v40, 0x3f803f80
    v_mov_b32 v41, 0x3f803f80
    v_mov_b32 v42, 0x3f803f80
    v_mov_b32 v43, 0x3f803f80
    v_mov_b32 v44, 0x3f803f80
    v_mov_b32 v45, 0x3f803f80
    v_mov_b32 v46, 0x3f803f80
    v_mov_b32 v47, 0x3f803f80
    s_cmp_ge_u32 s40, 4
    s_cbranch_scc1 K2_gb
    v_mov_b32 v48, 0
    v_mov_b32 v49, 0
    v_mov_b32 v50, 0
    v_mov_b32 v51, 0
    v_mov_b32 v52, 0
    v_mov_b32 v53, 0
    v_mov_b32 v54, 0
    v_mov_b32 v55, 0
    s_add_u32 s56, s69, 0
    s_and_b32 s56, s56, 7
    s_mul_i32 s56, s56, 2368
    s_add_u32 s56, s56, s54
    buffer_load_dwordx4 v[8:11], v3, s[24:27], s56 offen
    s_mov_b64 exec, s[58:59]
    buffer_load_dword v40, v2, s[24:27], s56 offen offset:1024
    s_mov_b64 exec, s[60:61]
    buffer_load_dwordx4 v[48:51], v4, s[24:27], s56 offen offset:1152
    buffer_load_dwordx4 v[52:55], v4, s[24:27], s56 offen offset:1760
    s_mov_b64 exec, -1
    v_mov_b32 v56, 0
    v_mov_b32 v57, 0
    v_mov_b32 v58, 0
    v_mov_b32 v59, 0
    v_mov_b32 v60, 0
    v_mov_b32 v61, 0
    v_mov_b32 v62, 0
    v_mov_b32 v63, 0
    s_add_u32 s56, s69, 1
    s_and_b32 s56, s56, 7
    s_mul_i32 s56, s56, 2368
    s_add_u32 s56, s56, s54
    buffer_load_dwordx4 v[12:15], v3, s[24:27], s56 offen
    s_mov_b64 exec, s[58:59]
    buffer_load_dword v41, v2, s[24:27], s56 offen offset:1024
    s_mov_b64 exec, s[60:61]
    buffer_load_dwordx4 v[56:59], v4, s[24:27], s56 offen offset:1152
    buffer_load_dwordx4 v[60:63], v4, s[24:27], s56 offen offset:1760
    s_mov_b64 exec, -1
    v_mov_b32 v64, 0
    v_mov_b32 v65, 0
    v_mov_b32 v66, 0
    v_mov_b32 v67, 0
    v_mov_b32 v68, 0
    v_mov_b32 v69, 0
    v_mov_b32 v70, 0
    v_mov_b32 v71, 0
    s_add_u32 s56, s69, 2
    s_and_b32 s56, s56, 7
    s_mul_i32 s56, s56, 2368
    s_add_u32 s56, s56, s54
    buffer_load_dwordx4 v[16:19], v3, s[24:27], s56 offen
    s_mov_b64 exec, s[58:59]
    buffer_load_dword v42, v2, s[24:27], s56 offen offset:1024
    s_mov_b64 exec, s[60:61]
    buffer_load_dwordx4 v[64:67], v4, s[24:27], s56 offen offset:1152
    buffer_load_dwordx4 v[68:71], v4, s[24:27], s56 offen offset:1760
    s_mov_b64 exec, -1
    v_mov_b32 v72, 0
    v_mov_b32 v73, 0
    v_mov_b32 v74, 0
    v_mov_b32 v75, 0
    v_mov_b32 v76, 0
    v_mov_b32 v77, 0
    v_mov_b32 v78, 0
    v_mov_b32 v79, 0
    v_mov_b32 v80, 0
    v_mov_b32 v81, 0
    v_mov_b32 v82, 0
    v_mov_b32 v83, 0
    v_mov_b32 v84, 0
    v_mov_b32 v85, 0
    v_mov_b32 v86, 0
    v_mov_b32 v87, 0
    v_mov_b32 v88, 0
    v_mov_b32 v89, 0
    v_mov_b32 v90, 0
    v_mov_b32 v91, 0
    v_mov_b32 v92, 0
    v_mov_b32 v93, 0
    v_mov_b32 v94, 0
    v_mov_b32 v95, 0
    v_mov_b32 v96, 0
    v_mov_b32 v97, 0
    v_mov_b32 v98, 0
    v_mov_b32 v99, 0
    v_mov_b32 v100, 0
    v_mov_b32 v101, 0
    v_mov_b32 v102, 0
    v_mov_b32 v103, 0
    v_mov_b32 v104, 0
    v_mov_b32 v105, 0
    v_mov_b32 v106, 0
    v_mov_b32 v107, 0
    v_mov_b32 v108, 0
    v_mov_b32 v109, 0
    v_mov_b32 v110, 0
    v_mov_b32 v111, 0
    s_setprio 1
    s_waitcnt vmcnt(12)
    v_cndmask_b32 v164, 0, v150, s[58:59]
    v_mov_b32 v165, 0
    v_mfma_f32_32x32x16_bf16 v[112:127], v[144:147], v[160:163], 0
    s_nop 0
    v_mfma_f32_32x32x8_bf16 v[112:127], v[148:149], v[164:165], v[112:127]
    s_nop 11
    v_max3_f32 v133, v112, v113, v114
    v_max3_f32 v133, v133, v115, v116
    v_max3_f32 v133, v133, v117, v118
    v_max3_f32 v133, v133, v119, v120
    v_max3_f32 v133, v133, v121, v122
    v_max3_f32 v133, v133, v123, v124
    v_max3_f32 v133, v133, v125, v126
    v_max_f32 v133, v133, v127
    v_mov_b32 v128, v133
    s_nop 1
    v_permlane32_swap_b32 v133, v128
    v_max_f32 v133, v133, v128
    v_add_f32 v133, 0x42c00000, v133
    v_sub_f32 v128, 0, v133
    v_and_b32 v129, 0xffff0000, v128
    v_sub_f32 v128, v128, v129
    v_and_b32 v130, 0xffff0000, v128
    v_sub_f32 v128, v128, v130
    v_lshrrev_b32 v129, 16, v129
    v_or_b32 v129, v129, v130
    v_lshrrev_b32 v128, 16, v128
    v_cndmask_b32 v164, v129, v150, s[58:59]
    v_cndmask_b32 v165, v128, 0, s[58:59]
    v_cndmask_b32 v166, v129, 0, s[58:59]
    v_cndmask_b32 v167, v128, v150, s[58:59]
    s_waitcnt vmcnt(10)
    s_branch K2_go
K2_gb:
    buffer_load_dwordx4 v[152:155], v136, s[24:27], s45 offen offset:144
    buffer_load_dword v151, v137, s[24:27], s45 offen offset:176
    v_mov_b32 v48, 0
    v_mov_b32 v49, 0
    v_mov_b32 v50, 0
    v_mov_b32 v51, 0
    v_mov_b32 v52, 0
    v_mov_b32 v53, 0
    v_mov_b32 v54, 0
    v_mov_b32 v55, 0
    v_mov_b32 v56, 0
    v_mov_b32 v57, 0
    v_mov_b32 v58, 0
    v_mov_b32 v59, 0
    v_mov_b32 v60, 0
    v_mov_b32 v61, 0
    v_mov_b32 v62, 0
    v_mov_b32 v63, 0
    v_mov_b32 v64, 0
    v_mov_b32 v65, 0
    v_mov_b32 v66, 0
    v_mov_b32 v67, 0
    v_mov_b32 v68, 0
    v_mov_b32 v69, 0
    v_mov_b32 v70, 0
    v_mov_b32 v71, 0
    v_mov_b32 v72, 0
    v_mov_b32 v73, 0
    v_mov_b32 v74, 0
    v_mov_b32 v75, 0
    v_mov_b32 v76, 0
    v_mov_b32 v77, 0
    v_mov_b32 v78, 0
    v_mov_b32 v79, 0
    v_mov_b32 v80, 0
    v_mov_b32 v81, 0
    v_mov_b32 v82, 0
    v_mov_b32 v83, 0
    v_mov_b32 v84, 0
    v_mov_b32 v85, 0
    v_mov_b32 v86, 0
    v_mov_b32 v87, 0
    v_mov_b32 v88, 0
    v_mov_b32 v89, 0
    v_mov_b32 v90, 0
    v_mov_b32 v91, 0
    v_mov_b32 v92, 0
    v_mov_b32 v93, 0
    v_mov_b32 v94, 0
    v_mov_b32 v95, 0
    v_mov_b32 v96, 0
    v_mov_b32 v97, 0
    v_mov_b32 v98, 0
    v_mov_b32 v99, 0
    v_mov_b32 v100, 0
    v_mov_b32 v101, 0
    v_mov_b32 v102, 0
    v_mov_b32 v103, 0
    v_mov_b32 v104, 0
    v_mov_b32 v105, 0
    v_mov_b32 v106, 0
    v_mov_b32 v107, 0
    v_mov_b32 v108, 0
    v_mov_b32 v109, 0
    v_mov_b32 v110, 0
    v_mov_b32 v111, 0
    s_lshl_b32 s46, s64, 12
    v_add_u32 v131, s46, v3
    s_waitcnt vmcnt(2)
    v_cndmask_b32 v164, 0, v150, s[58:59]
    v_mov_b32 v165, 0
    v_mfma_f32_32x32x16_bf16 v[112:127], v[144:147], v[160:163], 0
    s_nop 0
    v_mfma_f32_32x32x8_bf16 v[112:127], v[148:149], v[164:165], v[112:127]
    s_nop 11
    v_max3_f32 v133, v112, v113, v114
    v_max3_f32 v133, v133, v115, v116
    v_max3_f32 v133, v133, v117, v118
    v_max3_f32 v133, v133, v119, v120
    v_max3_f32 v133, v133, v121, v122
    v_max3_f32 v133, v133, v123, v124
    v_max3_f32 v133, v133, v125, v126
    v_max_f32 v133, v133, v127
    v_mov_b32 v128, v133
    s_nop 1
    v_permlane32_swap_b32 v133, v128
    v_max_f32 v133, v133, v128
    v_add_f32 v133, 0x42c00000, v133
    v_sub_f32 v128, 0, v133
    v_and_b32 v129, 0xffff0000, v128
    v_sub_f32 v128, v128, v129
    v_and_b32 v130, 0xffff0000, v128
    v_sub_f32 v128, v128, v130
    v_lshrrev_b32 v129, 16, v129
    v_or_b32 v129, v129, v130
    v_lshrrev_b32 v128, 16, v128
    v_cndmask_b32 v164, v129, v150, s[58:59]
    v_cndmask_b32 v165, v128, 0, s[58:59]
    v_cndmask_b32 v166, v129, 0, s[58:59]
    v_cndmask_b32 v167, v128, v150, s[58:59]
    ds_write_b128 v131, v[160:163] offset:0
    ds_write_b128 v131, v[164:167] offset:1024
    s_waitcnt vmcnt(0)
    v_cndmask_b32 v164, 0, v151, s[58:59]
    v_mov_b32 v165, 0
    v_mfma_f32_32x32x16_bf16 v[112:127], v[144:147], v[152:155], 0
    s_nop 0
    v_mfma_f32_32x32x8_bf16 v[112:127], v[148:149], v[164:165], v[112:127]
    s_nop 11
    v_max3_f32 v133, v112, v113, v114
    v_max3_f32 v133, v133, v115, v116
    v_max3_f32 v133, v133, v117, v118
    v_max3_f32 v133, v133, v119, v120
    v_max3_f32 v133, v133, v121, v122
    v_max3_f32 v133, v133, v123, v124
    v_max3_f32 v133, v133, v125, v126
    v_max_f32 v133, v133, v127
    v_mov_b32 v128, v133
    s_nop 1
    v_permlane32_swap_b32 v133, v128
    v_max_f32 v133, v133, v128
    v_add_f32 v133, 0x42c00000, v133
    v_sub_f32 v128, 0, v133
    v_and_b32 v129, 0xffff0000, v128
    v_sub_f32 v128, v128, v129
    v_and_b32 v130, 0xffff0000, v128
    v_sub_f32 v128, v128, v130
    v_lshrrev_b32 v129, 16, v129
    v_or_b32 v129, v129, v130
    v_lshrrev_b32 v128, 16, v128
    v_cndmask_b32 v164, v129, v151, s[58:59]
    v_cndmask_b32 v165, v128, 0, s[58:59]
    v_cndmask_b32 v166, v129, 0, s[58:59]
    v_cndmask_b32 v167, v128, v151, s[58:59]
    ds_write_b128 v131, v[152:155] offset:2048
    ds_write_b128 v131, v[164:167] offset:3072
    v_mov_b32 v128, 110372
    v_mov_b32 v129, 1
    s_mov_b64 exec, 1
    ds_add_u32 v128, v129
    s_mov_b64 exec, -1
    s_add_u32 s56, s69, 0
    s_and_b32 s56, s56, 7
    s_mul_i32 s56, s56, 2368
    s_add_u32 s56, s56, s54
    buffer_load_dwordx4 v[8:11], v3, s[24:27], s56 offen
    s_mov_b64 exec, s[58:59]
    buffer_load_dword v40, v2, s[24:27], s56 offen offset:1024
    s_mov_b64 exec, s[60:61]
    buffer_load_dwordx4 v[48:51], v4, s[24:27], s56 offen offset:1152
    buffer_load_dwordx4 v[52:55], v4, s[24:27], s56 offen offset:1760
    s_mov_b64 exec, -1
    s_add_u32 s56, s69, 1
    s_and_b32 s56, s56, 7
    s_mul_i32 s56, s56, 2368
    s_add_u32 s56, s56, s54
    buffer_load_dwordx4 v[12:15], v3, s[24:27], s56 offen
    s_mov_b64 exec, s[58:59]
    buffer_load_dword v41, v2, s[24:27], s56 offen offset:1024
    s_mov_b64 exec, s[60:61]
    buffer_load_dwordx4 v[56:59], v4, s[24:27], s56 offen offset:1152
    buffer_load_dwordx4 v[60:63], v4, s[24:27], s56 offen offset:1760
    s_mov_b64 exec, -1
    s_add_u32 s56, s69, 2
    s_and_b32 s56, s56, 7
    s_mul_i32 s56, s56, 2368
    s_add_u32 s56, s56, s54
    buffer_load_dwordx4 v[16:19], v3, s[24:27], s56 offen
    s_mov_b64 exec, s[58:59]
    buffer_load_dword v42, v2, s[24:27], s56 offen offset:1024
    s_mov_b64 exec, s[60:61]
    buffer_load_dwordx4 v[64:67], v4, s[24:27], s56 offen offset:1152
    buffer_load_dwordx4 v[68:71], v4, s[24:27], s56 offen offset:1760
    s_mov_b64 exec, -1
    s_add_u32 s56, s69, 3
    s_and_b32 s56, s56, 7
    s_mul_i32 s56, s56, 2368
    s_add_u32 s56, s56, s54
    buffer_load_dwordx4 v[20:23], v3, s[24:27], s56 offen
    s_mov_b64 exec, s[58:59]
    buffer_load_dword v43, v2, s[24:27], s56 offen offset:1024
    s_mov_b64 exec, s[60:61]
    buffer_load_dwordx4 v[72:75], v4, s[24:27], s56 offen offset:1152
    buffer_load_dwordx4 v[76:79], v4, s[24:27], s56 offen offset:1760
    s_mov_b64 exec, -1
    s_add_u32 s56, s69, 4
    s_and_b32 s56, s56, 7
    s_mul_i32 s56, s56, 2368
    s_add_u32 s56, s56, s54
    buffer_load_dwordx4 v[24:27], v3, s[24:27], s56 offen
    s_mov_b64 exec, s[58:59]
    buffer_load_dword v44, v2, s[24:27], s56 offen offset:1024
    s_mov_b64 exec, s[60:61]
    buffer_load_dwordx4 v[80:83], v4, s[24:27], s56 offen offset:1152
    buffer_load_dwordx4 v[84:87], v4, s[24:27], s56 offen offset:1760
    s_mov_b64 exec, -1
    s_add_u32 s56, s69, 5
    s_and_b32 s56, s56, 7
    s_mul_i32 s56, s56, 2368
    s_add_u32 s56, s56, s54
    buffer_load_dwordx4 v[28:31], v3, s[24:27], s56 offen
    s_mov_b64 exec, s[58:59]
    buffer_load_dword v45, v2, s[24:27], s56 offen offset:1024
    s_mov_b64 exec, s[60:61]
    buffer_load_dwordx4 v[88:91], v4, s[24:27], s56 offen offset:1152
    buffer_load_dwordx4 v[92:95], v4, s[24:27], s56 offen offset:1760
    s_mov_b64 exec, -1
    s_add_u32 s56, s69, 6
    s_and_b32 s56, s56, 7
    s_mul_i32 s56, s56, 2368
    s_add_u32 s56, s56, s54
    buffer_load_dwordx4 v[32:35], v3, s[24:27], s56 offen
    s_mov_b64 exec, s[58:59]
    buffer_load_dword v46, v2, s[24:27], s56 offen offset:1024
    s_mov_b64 exec, s[60:61]
    buffer_load_dwordx4 v[96:99], v4, s[24:27], s56 offen offset:1152
    buffer_load_dwordx4 v[100:103], v4, s[24:27], s56 offen offset:1760
    s_mov_b64 exec, -1
    s_add_u32 s56, s69, 7
    s_and_b32 s56, s56, 7
    s_mul_i32 s56, s56, 2368
    s_add_u32 s56, s56, s54
    buffer_load_dwordx4 v[36:39], v3, s[24:27], s56 offen
    s_mov_b64 exec, s[58:59]
    buffer_load_dword v47, v2, s[24:27], s56 offen offset:1024
    s_mov_b64 exec, s[60:61]
    buffer_load_dwordx4 v[104:107], v4, s[24:27], s56 offen offset:1152
    buffer_load_dwordx4 v[108:111], v4, s[24:27], s56 offen offset:1760
    s_mov_b64 exec, -1
K2_qlb:
    ds_read_b32 v129, v128
    s_waitcnt lgkmcnt(0)
    v_readfirstlane_b32 s45, v129
    s_cmp_lt_u32 s45, 4
    s_cbranch_scc1 K2_qlb
    ds_read_b128 v[160:163], v3 offset:0
    ds_read_b128 v[164:167], v3 offset:1024
    v_mov_b32 v128, 110364
    v_mov_b32 v129, 1
    s_waitcnt vmcnt(0)
    s_mov_b64 exec, 1
    ds_add_u32 v128, v129
    s_mov_b64 exec, -1
    s_waitcnt lgkmcnt(0)
K2_go:
    v_mfma_f32_32x32x16_bf16 v[112:127], v[8:11], v[160:163], 0
    v_mfma_f32_32x32x8_bf16 v[112:127], v[40:41], v[164:165], v[112:127]
    s_nop 7
    s_nop 3
    s_cmp_ge_u32 s40, 4
    s_cbranch_scc1 K2_runb
    v_exp_f32 v112, v112
    v_exp_f32 v113, v113
    v_exp_f32 v114, v114
    v_exp_f32 v115, v115
    v_exp_f32 v116, v116
    v_exp_f32 v117, v117
    s_waitcnt vmcnt(6)
    v_mfma_f32_32x32x16_bf16 v[128:143], v[12:15], v[160:163], 0
    v_exp_f32 v118, v118
    s_add_u32 s56, s69, 3
    s_and_b32 s56, s56, 7
    s_mul_i32 s56, s56, 2368
    s_add_u32 s56, s56, s54
    buffer_load_dwordx4 v[20:23], v3, s[24:27], s56 offen
    s_mov_b64 exec, s[58:59]
    buffer_load_dword v43, v2, s[24:27], s56 offen offset:1024
    s_mov_b64 exec, s[60:61]
    buffer_load_dwordx4 v[72:75], v4, s[24:27], s56 offen offset:1152
    buffer_load_dwordx4 v[76:79], v4, s[24:27], s56 offen offset:1760
    s_mov_b64 exec, -1
    s_add_u32 s56, s69, 4
    s_and_b32 s56, s56, 7
    s_mul_i32 s56, s56, 2368
    s_add_u32 s56, s56, s54
    buffer_load_dwordx4 v[24:27], v3, s[24:27], s56 offen
    s_mov_b64 exec, s[58:59]
    buffer_load_dword v44, v2, s[24:27], s56 offen offset:1024
    s_mov_b64 exec, s[60:61]
    buffer_load_dwordx4 v[80:83], v4, s[24:27], s56 offen offset:1152
    buffer_load_dwordx4 v[84:87], v4, s[24:27], s56 offen offset:1760
    s_mov_b64 exec, -1
    v_exp_f32 v119, v119
    v_cvt_pk_bf16_f32 v112, v112, v113
    v_cvt_pk_bf16_f32 v113, v114, v115
    v_cvt_pk_bf16_f32 v114, v116, v117
    v_cvt_pk_bf16_f32 v115, v118, v119
    v_exp_f32 v120, v120
    v_mfma_f32_32x32x8_bf16 v[128:143], v[40:41], v[166:167], v[128:143]
    v_exp_f32 v121, v121
    v_exp_f32 v122, v122
    v_exp_f32 v123, v123
    v_exp_f32 v124, v124
    v_mfma_f32_32x32x16_bf16 v[144:159], v[48:51], v[112:115], 0
    v_exp_f32 v125, v125
    v_exp_f32 v126, v126
    v_exp_f32 v127, v127
    v_cvt_pk_bf16_f32 v120, v120, v121
    v_cvt_pk_bf16_f32 v121, v122, v123
    v_cvt_pk_bf16_f32 v122, v124, v125
    v_cvt_pk_bf16_f32 v123, v126, v127
    v_exp_f32 v128, v128
    v_exp_f32 v129, v129
    v_mfma_f32_32x32x16_bf16 v[144:159], v[52:55], v[120:123], v[144:159]
    v_exp_f32 v130, v130
    v_exp_f32 v131, v131
    v_exp_f32 v132, v132
    v_exp_f32 v133, v133
    s_waitcnt vmcnt(10)
    v_mfma_f32_32x32x16_bf16 v[112:127], v[16:19], v[160:163], 0
    v_exp_f32 v134, v134
    s_add_u32 s56, s69, 5
    s_and_b32 s56, s56, 7
    s_mul_i32 s56, s56, 2368
    s_add_u32 s56, s56, s54
    buffer_load_dwordx4 v[28:31], v3, s[24:27], s56 offen
    s_mov_b64 exec, s[58:59]
    buffer_load_dword v45, v2, s[24:27], s56 offen offset:1024
    s_mov_b64 exec, s[60:61]
    buffer_load_dwordx4 v[88:91], v4, s[24:27], s56 offen offset:1152
    buffer_load_dwordx4 v[92:95], v4, s[24:27], s56 offen offset:1760
    s_mov_b64 exec, -1
    v_exp_f32 v135, v135
    v_cvt_pk_bf16_f32 v128, v128, v129
    v_cvt_pk_bf16_f32 v129, v130, v131
    v_cvt_pk_bf16_f32 v130, v132, v133
    v_cvt_pk_bf16_f32 v131, v134, v135
    v_exp_f32 v136, v136
    v_mfma_f32_32x32x8_bf16 v[112:127], v[42:43], v[164:165], v[112:127]
    v_exp_f32 v137, v137
    v_exp_f32 v138, v138
    v_exp_f32 v139, v139
    v_exp_f32 v140, v140
    v_mfma_f32_32x32x16_bf16 v[144:159], v[56:59], v[128:131], v[144:159]
    v_exp_f32 v141, v141
    v_exp_f32 v142, v142
    v_exp_f32 v143, v143
    v_cvt_pk_bf16_f32 v136, v136, v137
    v_cvt_pk_bf16_f32 v137, v138, v139
    v_cvt_pk_bf16_f32 v138, v140, v141
    v_cvt_pk_bf16_f32 v139, v142, v143
    v_exp_f32 v112, v112
    v_exp_f32 v113, v113
    v_mfma_f32_32x32x16_bf16 v[144:159], v[60:63], v[136:139], v[144:159]
    v_exp_f32 v114, v114
    v_exp_f32 v115, v115
    v_exp_f32 v116, v116
    v_exp_f32 v117, v117
    s_waitcnt vmcnt(10)
    v_mfma_f32_32x32x16_bf16 v[128:143], v[20:23], v[160:163], 0
    v_exp_f32 v118, v118
    s_add_u32 s56, s69, 6
    s_and_b32 s56, s56, 7
    s_mul_i32 s56, s56, 2368
    s_add_u32 s56, s56, s54
    buffer_load_dwordx4 v[32:35], v3, s[24:27], s56 offen
    s_mov_b64 exec, s[58:59]
    buffer_load_dword v46, v2, s[24:27], s56 offen offset:1024
    s_mov_b64 exec, s[60:61]
    buffer_load_dwordx4 v[96:99], v4, s[24:27], s56 offen offset:1152
    buffer_load_dwordx4 v[100:103], v4, s[24:27], s56 offen offset:1760
    s_mov_b64 exec, -1
    v_exp_f32 v119, v119
    v_cvt_pk_bf16_f32 v112, v112, v113
    v_cvt_pk_bf16_f32 v113, v114, v115
    v_cvt_pk_bf16_f32 v114, v116, v117
    v_cvt_pk_bf16_f32 v115, v118, v119
    v_exp_f32 v120, v120
    v_mfma_f32_32x32x8_bf16 v[128:143], v[42:43], v[166:167], v[128:143]
    v_exp_f32 v121, v121
    v_exp_f32 v122, v122
    v_exp_f32 v123, v123
    v_exp_f32 v124, v124
    v_mfma_f32_32x32x16_bf16 v[144:159], v[64:67], v[112:115], v[144:159]
    v_exp_f32 v125, v125
    v_exp_f32 v126, v126
    v_exp_f32 v127, v127
    v_cvt_pk_bf16_f32 v120, v120, v121
    v_cvt_pk_bf16_f32 v121, v122, v123
    v_cvt_pk_bf16_f32 v122, v124, v125
    v_cvt_pk_bf16_f32 v123, v126, v127
    v_exp_f32 v128, v128
    v_exp_f32 v129, v129
    v_mfma_f32_32x32x16_bf16 v[144:159], v[68:71], v[120:123], v[144:159]
    v_exp_f32 v130, v130
    v_exp_f32 v131, v131
    v_exp_f32 v132, v132
    v_exp_f32 v133, v133
    s_waitcnt vmcnt(10)
    v_mfma_f32_32x32x16_bf16 v[112:127], v[24:27], v[160:163], 0
    v_exp_f32 v134, v134
    s_add_u32 s56, s69, 7
    s_and_b32 s56, s56, 7
    s_mul_i32 s56, s56, 2368
    s_add_u32 s56, s56, s54
    buffer_load_dwordx4 v[36:39], v3, s[24:27], s56 offen
    s_mov_b64 exec, s[58:59]
    buffer_load_dword v47, v2, s[24:27], s56 offen offset:1024
    s_mov_b64 exec, s[60:61]
    buffer_load_dwordx4 v[104:107], v4, s[24:27], s56 offen offset:1152
    buffer_load_dwordx4 v[108:111], v4, s[24:27], s56 offen offset:1760
    s_mov_b64 exec, -1
    v_exp_f32 v135, v135
    v_cvt_pk_bf16_f32 v128, v128, v129
    v_cvt_pk_bf16_f32 v129, v130, v131
    v_cvt_pk_bf16_f32 v130, v132, v133
    v_cvt_pk_bf16_f32 v131, v134, v135
    v_exp_f32 v136, v136
    v_mfma_f32_32x32x8_bf16 v[112:127], v[44:45], v[164:165], v[112:127]
    v_exp_f32 v137, v137
    v_exp_f32 v138, v138
    v_exp_f32 v139, v139
    v_exp_f32 v140, v140
    v_mfma_f32_32x32x16_bf16 v[144:159], v[72:75], v[128:131], v[144:159]
    v_exp_f32 v141, v141
    v_exp_f32 v142, v142
    v_exp_f32 v143, v143
    v_cvt_pk_bf16_f32 v136, v136, v137
    v_cvt_pk_bf16_f32 v137, v138, v139
    v_cvt_pk_bf16_f32 v138, v140, v141
    v_cvt_pk_bf16_f32 v139, v142, v143
    v_exp_f32 v112, v112
    v_exp_f32 v113, v113
    v_mfma_f32_32x32x16_bf16 v[144:159], v[76:79], v[136:139], v[144:159]
    v_exp_f32 v114, v114
    v_exp_f32 v115, v115
    v_exp_f32 v116, v116
    v_exp_f32 v117, v117
    s_waitcnt vmcnt(10)
    v_mfma_f32_32x32x16_bf16 v[128:143], v[28:31], v[160:163], 0
    v_exp_f32 v118, v118
    v_exp_f32 v119, v119
    v_cvt_pk_bf16_f32 v112, v112, v113
    v_cvt_pk_bf16_f32 v113, v114, v115
    v_cvt_pk_bf16_f32 v114, v116, v117
    v_cvt_pk_bf16_f32 v115, v118, v119
    v_exp_f32 v120, v120
    v_mfma_f32_32x32x8_bf16 v[128:143], v[44:45], v[166:167], v[128:143]
    v_exp_f32 v121, v121
    v_exp_f32 v122, v122
    v_exp_f32 v123, v123
    v_exp_f32 v124, v124
    v_mfma_f32_32x32x16_bf16 v[144:159], v[80:83], v[112:115], v[144:159]
    v_exp_f32 v125, v125
    v_exp_f32 v126, v126
    v_exp_f32 v127, v127
    v_cvt_pk_bf16_f32 v120, v120, v121
    v_cvt_pk_bf16_f32 v121, v122, v123
    v_cvt_pk_bf16_f32 v122, v124, v125
    v_cvt_pk_bf16_f32 v123, v126, v127
    v_exp_f32 v128, v128
    v_exp_f32 v129, v129
    v_mfma_f32_32x32x16_bf16 v[144:159], v[84:87], v[120:123], v[144:159]
    v_exp_f32 v130, v130
    v_exp_f32 v131, v131
    v_exp_f32 v132, v132
    v_exp_f32 v133, v133
    s_waitcnt vmcnt(6)
    v_mfma_f32_32x32x16_bf16 v[112:127], v[32:35], v[160:163], 0
    v_exp_f32 v134, v134
    v_exp_f32 v135, v135
    v_cvt_pk_bf16_f32 v128, v128, v129
    v_cvt_pk_bf16_f32 v129, v130, v131
    v_cvt_pk_bf16_f32 v130, v132, v133
    v_cvt_pk_bf16_f32 v131, v134, v135
    v_exp_f32 v136, v136
    v_mfma_f32_32x32x8_bf16 v[112:127], v[46:47], v[164:165], v[112:127]
    v_exp_f32 v137, v137
    v_exp_f32 v138, v138
    v_exp_f32 v139, v139
    v_exp_f32 v140, v140
    v_mfma_f32_32x32x16_bf16 v[144:159], v[88:91], v[128:131], v[144:159]
    v_exp_f32 v141, v141
    v_exp_f32 v142, v142
    v_exp_f32 v143, v143
    v_cvt_pk_bf16_f32 v136, v136, v137
    v_cvt_pk_bf16_f32 v137, v138, v139
    v_cvt_pk_bf16_f32 v138, v140, v141
    v_cvt_pk_bf16_f32 v139, v142, v143
    v_exp_f32 v112, v112
    v_exp_f32 v113, v113
    v_mfma_f32_32x32x16_bf16 v[144:159], v[92:95], v[136:139], v[144:159]
    v_exp_f32 v114, v114
    v_exp_f32 v115, v115
    v_exp_f32 v116, v116
    v_exp_f32 v117, v117
    s_waitcnt vmcnt(2)
    v_mfma_f32_32x32x16_bf16 v[128:143], v[36:39], v[160:163], 0
    v_exp_f32 v118, v118
    v_mov_b32 v2, 110372
K2_qla:
    ds_read_b32 v0, v2
    s_waitcnt lgkmcnt(0)
    v_readfirstlane_b32 s45, v0
    s_cmp_lt_u32 s45, 4
    s_cbranch_scc1 K2_qla
    ds_read_b128 v[160:163], v5 offset:0
    v_exp_f32 v119, v119
    v_cvt_pk_bf16_f32 v112, v112, v113
    v_cvt_pk_bf16_f32 v113, v114, v115
    v_cvt_pk_bf16_f32 v114, v116, v117
    v_cvt_pk_bf16_f32 v115, v118, v119
    v_exp_f32 v120, v120
    v_mfma_f32_32x32x8_bf16 v[128:143], v[46:47], v[166:167], v[128:143]
    v_exp_f32 v121, v121
    ds_read_b128 v[164:167], v5 offset:1024
    v_exp_f32 v122, v122
    v_exp_f32 v123, v123
    v_exp_f32 v124, v124
    v_mfma_f32_32x32x16_bf16 v[144:159], v[96:99], v[112:115], v[144:159]
    v_exp_f32 v125, v125
    v_exp_f32 v126, v126
    v_exp_f32 v127, v127
    v_cvt_pk_bf16_f32 v120, v120, v121
    v_cvt_pk_bf16_f32 v121, v122, v123
    v_cvt_pk_bf16_f32 v122, v124, v125
    v_cvt_pk_bf16_f32 v123, v126, v127
    v_exp_f32 v128, v128
    v_exp_f32 v129, v129
    v_mfma_f32_32x32x16_bf16 v[144:159], v[100:103], v[120:123], v[144:159]
    v_exp_f32 v130, v130
    v_exp_f32 v131, v131
    v_exp_f32 v132, v132
    v_exp_f32 v133, v133
    s_waitcnt vmcnt(0)
    s_waitcnt lgkmcnt(0)
    v_mfma_f32_32x32x16_bf16 v[112:127], v[8:11], v[160:163], 0
    v_exp_f32 v134, v134
    v_exp_f32 v135, v135
    v_cvt_pk_bf16_f32 v128, v128, v129
    v_cvt_pk_bf16_f32 v129, v130, v131
    v_cvt_pk_bf16_f32 v130, v132, v133
    v_cvt_pk_bf16_f32 v131, v134, v135
    v_exp_f32 v136, v136
    v_mfma_f32_32x32x8_bf16 v[112:127], v[40:41], v[164:165], v[112:127]
    v_exp_f32 v137, v137
    v_exp_f32 v138, v138
    v_exp_f32 v139, v139
    v_exp_f32 v140, v140
    v_mfma_f32_32x32x16_bf16 v[144:159], v[104:107], v[128:131], v[144:159]
    v_exp_f32 v141, v141
    s_add_u32 s52, s52, 1
    s_cmp_lt_u32 s52, 8
    v_exp_f32 v142, v142
    v_exp_f32 v143, v143
    v_cvt_pk_bf16_f32 v136, v136, v137
    v_cvt_pk_bf16_f32 v137, v138, v139
    v_cvt_pk_bf16_f32 v138, v140, v141
    v_cvt_pk_bf16_f32 v139, v142, v143
K2_loopa:
    v_exp_f32 v112, v112
    v_exp_f32 v113, v113
    v_mfma_f32_32x32x16_bf16 v[144:159], v[108:111], v[136:139], v[144:159]
    v_exp_f32 v114, v114
    v_exp_f32 v115, v115
    v_exp_f32 v116, v116
    v_exp_f32 v117, v117
    v_mfma_f32_32x32x16_bf16 v[128:143], v[12:15], v[160:163], 0
    v_exp_f32 v118, v118
    v_exp_f32 v119, v119
    v_cvt_pk_bf16_f32 v112, v112, v113
    v_cvt_pk_bf16_f32 v113, v114, v115
    v_cvt_pk_bf16_f32 v114, v116, v117
    v_cvt_pk_bf16_f32 v115, v118, v119
    v_exp_f32 v120, v120
    v_mov_b32 v155, s52
    ds_write_b128 v6, v[144:147]
    ds_write_b128 v6, v[148:151] offset:1024
    s_mov_b64 exec, s[58:59]
    ds_write_b128 v6, v[152:155] offset:2048
    s_mov_b64 exec, -1
    v_mfma_f32_32x32x8_bf16 v[128:143], v[40:41], v[166:167], v[128:143]
    v_exp_f32 v121, v121
    v_exp_f32 v122, v122
    v_exp_f32 v123, v123
    v_exp_f32 v124, v124
    v_mfma_f32_32x32x16_bf16 v[144:159], v[48:51], v[112:115], 0
    v_exp_f32 v125, v125
    v_exp_f32 v126, v126
    v_exp_f32 v127, v127
    v_cvt_pk_bf16_f32 v120, v120, v121
    v_cvt_pk_bf16_f32 v121, v122, v123
    v_cvt_pk_bf16_f32 v122, v124, v125
    v_cvt_pk_bf16_f32 v123, v126, v127
    v_exp_f32 v128, v128
    v_exp_f32 v129, v129
    v_mfma_f32_32x32x16_bf16 v[144:159], v[52:55], v[120:123], v[144:159]
    v_exp_f32 v130, v130
    v_exp_f32 v131, v131
    v_exp_f32 v132, v132
    v_exp_f32 v133, v133
    v_mfma_f32_32x32x16_bf16 v[112:127], v[16:19], v[160:163], 0
    v_exp_f32 v134, v134
    v_exp_f32 v135, v135
    v_cvt_pk_bf16_f32 v128, v128, v129
    v_cvt_pk_bf16_f32 v129, v130, v131
    v_cvt_pk_bf16_f32 v130, v132, v133
    v_cvt_pk_bf16_f32 v131, v134, v135
    v_exp_f32 v136, v136
    v_mfma_f32_32x32x8_bf16 v[112:127], v[42:43], v[164:165], v[112:127]
    v_exp_f32 v137, v137
    v_exp_f32 v138, v138
    v_exp_f32 v139, v139
    v_exp_f32 v140, v140
    v_mfma_f32_32x32x16_bf16 v[144:159], v[56:59], v[128:131], v[144:159]
    v_exp_f32 v141, v141
    v_exp_f32 v142, v142
    v_exp_f32 v143, v143
    v_cvt_pk_bf16_f32 v136, v136, v137
    v_cvt_pk_bf16_f32 v137, v138, v139
    v_cvt_pk_bf16_f32 v138, v140, v141
    v_cvt_pk_bf16_f32 v139, v142, v143
    v_exp_f32 v112, v112
    v_exp_f32 v113, v113
    v_mfma_f32_32x32x16_bf16 v[144:159], v[60:63], v[136:139], v[144:159]
    v_exp_f32 v114, v114
    v_exp_f32 v115, v115
    v_exp_f32 v116, v116
    v_exp_f32 v117, v117
    v_mfma_f32_32x32x16_bf16 v[128:143], v[20:23], v[160:163], 0
    v_exp_f32 v118, v118
    v_exp_f32 v119, v119
    v_cvt_pk_bf16_f32 v112, v112, v113
    v_cvt_pk_bf16_f32 v113, v114, v115
    v_cvt_pk_bf16_f32 v114, v116, v117
    v_cvt_pk_bf16_f32 v115, v118, v119
    v_exp_f32 v120, v120
    v_mfma_f32_32x32x8_bf16 v[128:143], v[42:43], v[166:167], v[128:143]
    v_exp_f32 v121, v121
    v_exp_f32 v122, v122
    v_exp_f32 v123, v123
    v_exp_f32 v124, v124
    s_and_b32 s45, s52, 3
    s_mul_i32 s45, s45, 20480
    s_add_u32 s45, s45, s63
    v_add_u32 v6, s45, v3
    v_add_u32 v7, 4, v7
    v_add_u32 v5, 2048, v5
    s_lshr_b32 s65, s52, 2
    v_mfma_f32_32x32x16_bf16 v[144:159], v[64:67], v[112:115], v[144:159]
    v_exp_f32 v125, v125
    v_exp_f32 v126, v126
    v_exp_f32 v127, v127
    v_cvt_pk_bf16_f32 v120, v120, v121
    v_cvt_pk_bf16_f32 v121, v122, v123
    v_cvt_pk_bf16_f32 v122, v124, v125
    v_cvt_pk_bf16_f32 v123, v126, v127
    v_exp_f32 v128, v128
    v_exp_f32 v129, v129
    v_mfma_f32_32x32x16_bf16 v[144:159], v[68:71], v[120:123], v[144:159]
    v_exp_f32 v130, v130
    v_exp_f32 v131, v131
    v_exp_f32 v132, v132
    v_exp_f32 v133, v133
    v_mfma_f32_32x32x16_bf16 v[112:127], v[24:27], v[160:163], 0
    v_exp_f32 v134, v134
    v_exp_f32 v135, v135
    v_cvt_pk_bf16_f32 v128, v128, v129
    v_cvt_pk_bf16_f32 v129, v130, v131
    v_cvt_pk_bf16_f32 v130, v132, v133
    v_cvt_pk_bf16_f32 v131, v134, v135
    v_exp_f32 v136, v136
    v_mfma_f32_32x32x8_bf16 v[112:127], v[44:45], v[164:165], v[112:127]
    v_exp_f32 v137, v137
    v_exp_f32 v138, v138
    v_exp_f32 v139, v139
    v_exp_f32 v140, v140
    v_mfma_f32_32x32x16_bf16 v[144:159], v[72:75], v[128:131], v[144:159]
    v_exp_f32 v141, v141
    v_exp_f32 v142, v142
    v_exp_f32 v143, v143
    v_cvt_pk_bf16_f32 v136, v136, v137
    v_cvt_pk_bf16_f32 v137, v138, v139
    v_cvt_pk_bf16_f32 v138, v140, v141
    v_cvt_pk_bf16_f32 v139, v142, v143
    v_exp_f32 v112, v112
    v_exp_f32 v113, v113
    v_mfma_f32_32x32x16_bf16 v[144:159], v[76:79], v[136:139], v[144:159]
    v_exp_f32 v114, v114
    v_exp_f32 v115, v115
    v_exp_f32 v116, v116
    v_exp_f32 v117, v117
    v_mfma_f32_32x32x16_bf16 v[128:143], v[28:31], v[160:163], 0
    v_exp_f32 v118, v118
    v_exp_f32 v119, v119
    v_cvt_pk_bf16_f32 v112, v112, v113
    v_cvt_pk_bf16_f32 v113, v114, v115
    v_cvt_pk_bf16_f32 v114, v116, v117
    v_cvt_pk_bf16_f32 v115, v118, v119
    v_exp_f32 v120, v120
    v_mfma_f32_32x32x8_bf16 v[128:143], v[44:45], v[166:167], v[128:143]
    v_exp_f32 v121, v121
    v_exp_f32 v122, v122
    v_exp_f32 v123, v123
    v_exp_f32 v124, v124
    v_mfma_f32_32x32x16_bf16 v[144:159], v[80:83], v[112:115], v[144:159]
    v_exp_f32 v125, v125
    v_exp_f32 v126, v126
    v_exp_f32 v127, v127
    v_cvt_pk_bf16_f32 v120, v120, v121
    v_cvt_pk_bf16_f32 v121, v122, v123
    v_cvt_pk_bf16_f32 v122, v124, v125
    v_cvt_pk_bf16_f32 v123, v126, v127
    v_exp_f32 v128, v128
    v_exp_f32 v129, v129
    v_mfma_f32_32x32x16_bf16 v[144:159], v[84:87], v[120:123], v[144:159]
    v_exp_f32 v130, v130
    v_exp_f32 v131, v131
    v_exp_f32 v132, v132
    v_exp_f32 v133, v133
    v_mfma_f32_32x32x16_bf16 v[112:127], v[32:35], v[160:163], 0
    v_exp_f32 v134, v134
    v_exp_f32 v135, v135
    v_cvt_pk_bf16_f32 v128, v128, v129
    v_cvt_pk_bf16_f32 v129, v130, v131
    v_cvt_pk_bf16_f32 v130, v132, v133
    v_cvt_pk_bf16_f32 v131, v134, v135
    v_exp_f32 v136, v136
    v_mfma_f32_32x32x8_bf16 v[112:127], v[46:47], v[164:165], v[112:127]
    v_exp_f32 v137, v137
    v_exp_f32 v138, v138
    v_exp_f32 v139, v139
    v_exp_f32 v140, v140
    v_mfma_f32_32x32x16_bf16 v[144:159], v[88:91], v[128:131], v[144:159]
    v_exp_f32 v141, v141
    v_exp_f32 v142, v142
    v_exp_f32 v143, v143
    v_cvt_pk_bf16_f32 v136, v136, v137
    v_cvt_pk_bf16_f32 v137, v138, v139
    v_cvt_pk_bf16_f32 v138, v140, v141
    v_cvt_pk_bf16_f32 v139, v142, v143
    v_exp_f32 v112, v112
    v_exp_f32 v113, v113
    v_mfma_f32_32x32x16_bf16 v[144:159], v[92:95], v[136:139], v[144:159]
    v_exp_f32 v114, v114
    v_exp_f32 v115, v115
    v_exp_f32 v116, v116
    v_exp_f32 v117, v117
    v_mfma_f32_32x32x16_bf16 v[128:143], v[36:39], v[160:163], 0
    v_exp_f32 v118, v118
    ds_read_b128 v[160:163], v5 offset:0
    v_exp_f32 v119, v119
    v_cvt_pk_bf16_f32 v112, v112, v113
    v_cvt_pk_bf16_f32 v113, v114, v115
    v_cvt_pk_bf16_f32 v114, v116, v117
    v_cvt_pk_bf16_f32 v115, v118, v119
    v_exp_f32 v120, v120
    v_mfma_f32_32x32x8_bf16 v[128:143], v[46:47], v[166:167], v[128:143]
    v_exp_f32 v121, v121
    ds_read_b128 v[164:167], v5 offset:1024
    ds_read_b32 v0, v7
    v_exp_f32 v122, v122
    v_exp_f32 v123, v123
    v_exp_f32 v124, v124
    v_mfma_f32_32x32x16_bf16 v[144:159], v[96:99], v[112:115], v[144:159]
    v_exp_f32 v125, v125
    v_exp_f32 v126, v126
    v_exp_f32 v127, v127
    v_cvt_pk_bf16_f32 v120, v120, v121
    v_cvt_pk_bf16_f32 v121, v122, v123
    v_cvt_pk_bf16_f32 v122, v124, v125
    v_cvt_pk_bf16_f32 v123, v126, v127
    v_exp_f32 v128, v128
    v_exp_f32 v129, v129
    v_mfma_f32_32x32x16_bf16 v[144:159], v[100:103], v[120:123], v[144:159]
    v_exp_f32 v130, v130
    v_exp_f32 v131, v131
    v_exp_f32 v132, v132
    v_exp_f32 v133, v133
    s_waitcnt lgkmcnt(0)
    v_mfma_f32_32x32x16_bf16 v[112:127], v[8:11], v[160:163], 0
    v_exp_f32 v134, v134
    v_readfirstlane_b32 s45, v0
    v_exp_f32 v135, v135
    v_cvt_pk_bf16_f32 v128, v128, v129
    v_cvt_pk_bf16_f32 v129, v130, v131
    v_cvt_pk_bf16_f32 v130, v132, v133
    v_cvt_pk_bf16_f32 v131, v134, v135
    v_exp_f32 v136, v136
    s_cmp_lt_u32 s45, s65
    s_cbranch_scc1 K2_fwla
K2_fola:
    v_mfma_f32_32x32x8_bf16 v[112:127], v[40:41], v[164:165], v[112:127]
    v_exp_f32 v137, v137
    v_exp_f32 v138, v138
    v_exp_f32 v139, v139
    v_exp_f32 v140, v140
    v_mfma_f32_32x32x16_bf16 v[144:159], v[104:107], v[128:131], v[144:159]
    v_exp_f32 v141, v141
    s_add_u32 s52, s52, 1
    s_cmp_lt_u32 s52, 8
    v_exp_f32 v142, v142
    v_exp_f32 v143, v143
    v_cvt_pk_bf16_f32 v136, v136, v137
    v_cvt_pk_bf16_f32 v137, v138, v139
    v_cvt_pk_bf16_f32 v138, v140, v141
    v_cvt_pk_bf16_f32 v139, v142, v143
    s_cbranch_scc1 K2_loopa
    s_branch K2_ran
K2_runb:
    s_setprio 2
    v_exp_f32 v112, v112
    v_exp_f32 v113, v113
    v_exp_f32 v114, v114
    v_exp_f32 v115, v115
    v_exp_f32 v116, v116
    v_exp_f32 v117, v117
    v_mfma_f32_32x32x16_bf16 v[128:143], v[12:15], v[160:163], 0
    v_exp_f32 v118, v118
    v_exp_f32 v119, v119
    v_cvt_pk_bf16_f32 v112, v112, v113
    v_cvt_pk_bf16_f32 v113, v114, v115
    v_cvt_pk_bf16_f32 v114, v116, v117
    v_cvt_pk_bf16_f32 v115, v118, v119
    v_exp_f32 v120, v120
    v_mfma_f32_32x32x8_bf16 v[128:143], v[40:41], v[166:167], v[128:143]
    v_exp_f32 v121, v121
    v_exp_f32 v122, v122
    v_exp_f32 v123, v123
    v_exp_f32 v124, v124
    v_mfma_f32_32x32x16_bf16 v[144:159], v[48:51], v[112:115], 0
    v_exp_f32 v125, v125
    v_exp_f32 v126, v126
    v_exp_f32 v127, v127
    v_cvt_pk_bf16_f32 v120, v120, v121
    v_cvt_pk_bf16_f32 v121, v122, v123
    v_cvt_pk_bf16_f32 v122, v124, v125
    v_cvt_pk_bf16_f32 v123, v126, v127
    v_exp_f32 v128, v128
    v_exp_f32 v129, v129
    v_mfma_f32_32x32x16_bf16 v[144:159], v[52:55], v[120:123], v[144:159]
    v_exp_f32 v130, v130
    v_exp_f32 v131, v131
    v_exp_f32 v132, v132
    v_exp_f32 v133, v133
    v_mfma_f32_32x32x16_bf16 v[112:127], v[16:19], v[160:163], 0
    v_exp_f32 v134, v134
    v_exp_f32 v135, v135
    v_cvt_pk_bf16_f32 v128, v128, v129
    v_cvt_pk_bf16_f32 v129, v130, v131
    v_cvt_pk_bf16_f32 v130, v132, v133
    v_cvt_pk_bf16_f32 v131, v134, v135
    v_exp_f32 v136, v136
    v_mfma_f32_32x32x8_bf16 v[112:127], v[42:43], v[164:165], v[112:127]
    v_exp_f32 v137, v137
    v_exp_f32 v138, v138
    v_exp_f32 v139, v139
    v_exp_f32 v140, v140
    v_mfma_f32_32x32x16_bf16 v[144:159], v[56:59], v[128:131], v[144:159]
    v_exp_f32 v141, v141
    v_exp_f32 v142, v142
    v_exp_f32 v143, v143
    v_cvt_pk_bf16_f32 v136, v136, v137
    v_cvt_pk_bf16_f32 v137, v138, v139
    v_cvt_pk_bf16_f32 v138, v140, v141
    v_cvt_pk_bf16_f32 v139, v142, v143
    v_exp_f32 v112, v112
    v_exp_f32 v113, v113
    v_mfma_f32_32x32x16_bf16 v[144:159], v[60:63], v[136:139], v[144:159]
    v_exp_f32 v114, v114
    v_exp_f32 v115, v115
    v_exp_f32 v116, v116
    v_exp_f32 v117, v117
    v_mfma_f32_32x32x16_bf16 v[128:143], v[20:23], v[160:163], 0
    v_exp_f32 v118, v118
    v_exp_f32 v119, v119
    v_cvt_pk_bf16_f32 v112, v112, v113
    v_cvt_pk_bf16_f32 v113, v114, v115
    v_cvt_pk_bf16_f32 v114, v116, v117
    v_cvt_pk_bf16_f32 v115, v118, v119
    v_exp_f32 v120, v120
    v_mfma_f32_32x32x8_bf16 v[128:143], v[42:43], v[166:167], v[128:143]
    v_exp_f32 v121, v121
    v_exp_f32 v122, v122
    v_exp_f32 v123, v123
    v_exp_f32 v124, v124
    v_mfma_f32_32x32x16_bf16 v[144:159], v[64:67], v[112:115], v[144:159]
    v_exp_f32 v125, v125
    v_exp_f32 v126, v126
    v_exp_f32 v127, v127
    v_cvt_pk_bf16_f32 v120, v120, v121
    v_cvt_pk_bf16_f32 v121, v122, v123
    v_cvt_pk_bf16_f32 v122, v124, v125
    v_cvt_pk_bf16_f32 v123, v126, v127
    v_exp_f32 v128, v128
    v_exp_f32 v129, v129
    v_mfma_f32_32x32x16_bf16 v[144:159], v[68:71], v[120:123], v[144:159]
    v_exp_f32 v130, v130
    v_exp_f32 v131, v131
    v_exp_f32 v132, v132
    v_exp_f32 v133, v133
    v_mfma_f32_32x32x16_bf16 v[112:127], v[24:27], v[160:163], 0
    v_exp_f32 v134, v134
    v_exp_f32 v135, v135
    v_cvt_pk_bf16_f32 v128, v128, v129
    v_cvt_pk_bf16_f32 v129, v130, v131
    v_cvt_pk_bf16_f32 v130, v132, v133
    v_cvt_pk_bf16_f32 v131, v134, v135
    v_exp_f32 v136, v136
    v_mfma_f32_32x32x8_bf16 v[112:127], v[44:45], v[164:165], v[112:127]
    v_exp_f32 v137, v137
    v_exp_f32 v138, v138
    v_exp_f32 v139, v139
    v_exp_f32 v140, v140
    v_mfma_f32_32x32x16_bf16 v[144:159], v[72:75], v[128:131], v[144:159]
    v_exp_f32 v141, v141
    v_exp_f32 v142, v142
    v_exp_f32 v143, v143
    v_cvt_pk_bf16_f32 v136, v136, v137
    v_cvt_pk_bf16_f32 v137, v138, v139
    v_cvt_pk_bf16_f32 v138, v140, v141
    v_cvt_pk_bf16_f32 v139, v142, v143
    v_exp_f32 v112, v112
    v_exp_f32 v113, v113
    v_mfma_f32_32x32x16_bf16 v[144:159], v[76:79], v[136:139], v[144:159]
    v_exp_f32 v114, v114
    v_exp_f32 v115, v115
    v_exp_f32 v116, v116
    v_exp_f32 v117, v117
    v_mfma_f32_32x32x16_bf16 v[128:143], v[28:31], v[160:163], 0
    v_exp_f32 v118, v118
    v_exp_f32 v119, v119
    v_cvt_pk_bf16_f32 v112, v112, v113
    v_cvt_pk_bf16_f32 v113, v114, v115
    v_cvt_pk_bf16_f32 v114, v116, v117
    v_cvt_pk_bf16_f32 v115, v118, v119
    v_exp_f32 v120, v120
    v_mfma_f32_32x32x8_bf16 v[128:143], v[44:45], v[166:167], v[128:143]
    v_exp_f32 v121, v121
    v_exp_f32 v122, v122
    v_exp_f32 v123, v123
    v_exp_f32 v124, v124
    v_mfma_f32_32x32x16_bf16 v[144:159], v[80:83], v[112:115], v[144:159]
    v_exp_f32 v125, v125
    v_exp_f32 v126, v126
    v_exp_f32 v127, v127
    v_cvt_pk_bf16_f32 v120, v120, v121
    v_cvt_pk_bf16_f32 v121, v122, v123
    v_cvt_pk_bf16_f32 v122, v124, v125
    v_cvt_pk_bf16_f32 v123, v126, v127
    v_exp_f32 v128, v128
    v_exp_f32 v129, v129
    v_mfma_f32_32x32x16_bf16 v[144:159], v[84:87], v[120:123], v[144:159]
    v_exp_f32 v130, v130
    v_exp_f32 v131, v131
    v_exp_f32 v132, v132
    v_exp_f32 v133, v133
    v_mfma_f32_32x32x16_bf16 v[112:127], v[32:35], v[160:163], 0
    v_exp_f32 v134, v134
    v_exp_f32 v135, v135
    v_cvt_pk_bf16_f32 v128, v128, v129
    v_cvt_pk_bf16_f32 v129, v130, v131
    v_cvt_pk_bf16_f32 v130, v132, v133
    v_cvt_pk_bf16_f32 v131, v134, v135
    v_exp_f32 v136, v136
    v_mfma_f32_32x32x8_bf16 v[112:127], v[46:47], v[164:165], v[112:127]
    v_exp_f32 v137, v137
    v_exp_f32 v138, v138
    v_exp_f32 v139, v139
    v_exp_f32 v140, v140
    v_mfma_f32_32x32x16_bf16 v[144:159], v[88:91], v[128:131], v[144:159]
    v_exp_f32 v141, v141
    v_exp_f32 v142, v142
    v_exp_f32 v143, v143
    v_cvt_pk_bf16_f32 v136, v136, v137
    v_cvt_pk_bf16_f32 v137, v138, v139
    v_cvt_pk_bf16_f32 v138, v140, v141
    v_cvt_pk_bf16_f32 v139, v142, v143
    v_exp_f32 v112, v112
    v_exp_f32 v113, v113
    v_mfma_f32_32x32x16_bf16 v[144:159], v[92:95], v[136:139], v[144:159]
    v_exp_f32 v114, v114
    v_exp_f32 v115, v115
    v_exp_f32 v116, v116
    v_exp_f32 v117, v117
    v_mfma_f32_32x32x16_bf16 v[128:143], v[36:39], v[160:163], 0
    v_exp_f32 v118, v118
    ds_read_b128 v[160:163], v5 offset:0
    v_exp_f32 v119, v119
    v_cvt_pk_bf16_f32 v112, v112, v113
    v_cvt_pk_bf16_f32 v113, v114, v115
    v_cvt_pk_bf16_f32 v114, v116, v117
    v_cvt_pk_bf16_f32 v115, v118, v119
    v_exp_f32 v120, v120
    v_mfma_f32_32x32x8_bf16 v[128:143], v[46:47], v[166:167], v[128:143]
    v_exp_f32 v121, v121
    ds_read_b128 v[164:167], v5 offset:1024
    v_exp_f32 v122, v122
    v_exp_f32 v123, v123
    v_exp_f32 v124, v124
    v_mfma_f32_32x32x16_bf16 v[144:159], v[96:99], v[112:115], v[144:159]
    v_exp_f32 v125, v125
    v_exp_f32 v126, v126
    v_exp_f32 v127, v127
    v_cvt_pk_bf16_f32 v120, v120, v121
    v_cvt_pk_bf16_f32 v121, v122, v123
    v_cvt_pk_bf16_f32 v122, v124, v125
    v_cvt_pk_bf16_f32 v123, v126, v127
    v_exp_f32 v128, v128
    v_exp_f32 v129, v129
    v_mfma_f32_32x32x16_bf16 v[144:159], v[100:103], v[120:123], v[144:159]
    v_exp_f32 v130, v130
    v_exp_f32 v131, v131
    s_setprio 0
    v_exp_f32 v132, v132
    v_exp_f32 v133, v133
    s_waitcnt lgkmcnt(0)
    v_mfma_f32_32x32x16_bf16 v[112:127], v[8:11], v[160:163], 0
    v_exp_f32 v134, v134
    v_exp_f32 v135, v135
    v_cvt_pk_bf16_f32 v128, v128, v129
    v_cvt_pk_bf16_f32 v129, v130, v131
    v_cvt_pk_bf16_f32 v130, v132, v133
    v_cvt_pk_bf16_f32 v131, v134, v135
    v_exp_f32 v136, v136
    v_mfma_f32_32x32x8_bf16 v[112:127], v[40:41], v[164:165], v[112:127]
    v_exp_f32 v137, v137
    v_exp_f32 v138, v138
    v_exp_f32 v139, v139
    v_exp_f32 v140, v140
    v_mfma_f32_32x32x16_bf16 v[144:159], v[104:107], v[128:131], v[144:159]
    v_exp_f32 v141, v141
    s_add_u32 s52, s52, 1
    s_cmp_lt_u32 s52, 8
    v_exp_f32 v142, v142
    v_exp_f32 v143, v143
    v_cvt_pk_bf16_f32 v136, v136, v137
    v_cvt_pk_bf16_f32 v137, v138, v139
    v_cvt_pk_bf16_f32 v138, v140, v141
    v_cvt_pk_bf16_f32 v139, v142, v143
K2_loopb:
    s_setprio 2
    v_exp_f32 v112, v112
    v_exp_f32 v113, v113
    v_mfma_f32_32x32x16_bf16 v[144:159], v[108:111], v[136:139], v[144:159]
    v_exp_f32 v114, v114
    v_exp_f32 v115, v115
    v_exp_f32 v116, v116
    v_exp_f32 v117, v117
    v_mfma_f32_32x32x16_bf16 v[128:143], v[12:15], v[160:163], 0
    v_exp_f32 v118, v118
    v_exp_f32 v119, v119
    v_cvt_pk_bf16_f32 v112, v112, v113
    v_cvt_pk_bf16_f32 v113, v114, v115
    v_cvt_pk_bf16_f32 v114, v116, v117
    v_cvt_pk_bf16_f32 v115, v118, v119
    v_exp_f32 v120, v120
    v_mov_b32 v155, s52
    ds_write_b128 v6, v[144:147]
    ds_write_b128 v6, v[148:151] offset:1024
    s_mov_b64 exec, s[58:59]
    ds_write_b128 v6, v[152:155] offset:2048
    s_mov_b64 exec, -1
    v_mfma_f32_32x32x8_bf16 v[128:143], v[40:41], v[166:167], v[128:143]
    v_exp_f32 v121, v121
    v_exp_f32 v122, v122
    v_exp_f32 v123, v123
    v_exp_f32 v124, v124
    v_mfma_f32_32x32x16_bf16 v[144:159], v[48:51], v[112:115], 0
    v_exp_f32 v125, v125
    v_exp_f32 v126, v126
    v_exp_f32 v127, v127
    v_cvt_pk_bf16_f32 v120, v120, v121
    v_cvt_pk_bf16_f32 v121, v122, v123
    v_cvt_pk_bf16_f32 v122, v124, v125
    v_cvt_pk_bf16_f32 v123, v126, v127
    v_exp_f32 v128, v128
    v_exp_f32 v129, v129
    v_mfma_f32_32x32x16_bf16 v[144:159], v[52:55], v[120:123], v[144:159]
    v_exp_f32 v130, v130
    v_exp_f32 v131, v131
    v_exp_f32 v132, v132
    v_exp_f32 v133, v133
    v_mfma_f32_32x32x16_bf16 v[112:127], v[16:19], v[160:163], 0
    v_exp_f32 v134, v134
    v_exp_f32 v135, v135
    v_cvt_pk_bf16_f32 v128, v128, v129
    v_cvt_pk_bf16_f32 v129, v130, v131
    v_cvt_pk_bf16_f32 v130, v132, v133
    v_cvt_pk_bf16_f32 v131, v134, v135
    v_exp_f32 v136, v136
    v_mfma_f32_32x32x8_bf16 v[112:127], v[42:43], v[164:165], v[112:127]
    v_exp_f32 v137, v137
    v_exp_f32 v138, v138
    v_exp_f32 v139, v139
    v_exp_f32 v140, v140
    v_mfma_f32_32x32x16_bf16 v[144:159], v[56:59], v[128:131], v[144:159]
    v_exp_f32 v141, v141
    v_exp_f32 v142, v142
    v_exp_f32 v143, v143
    v_cvt_pk_bf16_f32 v136, v136, v137
    v_cvt_pk_bf16_f32 v137, v138, v139
    v_cvt_pk_bf16_f32 v138, v140, v141
    v_cvt_pk_bf16_f32 v139, v142, v143
    v_exp_f32 v112, v112
    v_exp_f32 v113, v113
    v_mfma_f32_32x32x16_bf16 v[144:159], v[60:63], v[136:139], v[144:159]
    v_exp_f32 v114, v114
    v_exp_f32 v115, v115
    v_exp_f32 v116, v116
    v_exp_f32 v117, v117
    v_mfma_f32_32x32x16_bf16 v[128:143], v[20:23], v[160:163], 0
    v_exp_f32 v118, v118
    v_exp_f32 v119, v119
    v_cvt_pk_bf16_f32 v112, v112, v113
    v_cvt_pk_bf16_f32 v113, v114, v115
    v_cvt_pk_bf16_f32 v114, v116, v117
    v_cvt_pk_bf16_f32 v115, v118, v119
    v_exp_f32 v120, v120
    v_mfma_f32_32x32x8_bf16 v[128:143], v[42:43], v[166:167], v[128:143]
    v_exp_f32 v121, v121
    v_exp_f32 v122, v122
    v_exp_f32 v123, v123
    v_exp_f32 v124, v124
    s_and_b32 s45, s52, 3
    s_mul_i32 s45, s45, 20480
    s_add_u32 s45, s45, s63
    v_add_u32 v6, s45, v3
    v_add_u32 v7, 4, v7
    v_add_u32 v5, 2048, v5
    s_lshr_b32 s65, s52, 2
    v_mfma_f32_32x32x16_bf16 v[144:159], v[64:67], v[112:115], v[144:159]
    v_exp_f32 v125, v125
    v_exp_f32 v126, v126
    v_exp_f32 v127, v127
    v_cvt_pk_bf16_f32 v120, v120, v121
    v_cvt_pk_bf16_f32 v121, v122, v123
    v_cvt_pk_bf16_f32 v122, v124, v125
    v_cvt_pk_bf16_f32 v123, v126, v127
    v_exp_f32 v128, v128
    v_exp_f32 v129, v129
    v_mfma_f32_32x32x16_bf16 v[144:159], v[68:71], v[120:123], v[144:159]
    v_exp_f32 v130, v130
    v_exp_f32 v131, v131
    v_exp_f32 v132, v132
    v_exp_f32 v133, v133
    v_mfma_f32_32x32x16_bf16 v[112:127], v[24:27], v[160:163], 0
    v_exp_f32 v134, v134
    v_exp_f32 v135, v135
    v_cvt_pk_bf16_f32 v128, v128, v129
    v_cvt_pk_bf16_f32 v129, v130, v131
    v_cvt_pk_bf16_f32 v130, v132, v133
    v_cvt_pk_bf16_f32 v131, v134, v135
    v_exp_f32 v136, v136
    v_mfma_f32_32x32x8_bf16 v[112:127], v[44:45], v[164:165], v[112:127]
    v_exp_f32 v137, v137
    v_exp_f32 v138, v138
    v_exp_f32 v139, v139
    v_exp_f32 v140, v140
    v_mfma_f32_32x32x16_bf16 v[144:159], v[72:75], v[128:131], v[144:159]
    v_exp_f32 v141, v141
    v_exp_f32 v142, v142
    v_exp_f32 v143, v143
    v_cvt_pk_bf16_f32 v136, v136, v137
    v_cvt_pk_bf16_f32 v137, v138, v139
    v_cvt_pk_bf16_f32 v138, v140, v141
    v_cvt_pk_bf16_f32 v139, v142, v143
    v_exp_f32 v112, v112
    v_exp_f32 v113, v113
    v_mfma_f32_32x32x16_bf16 v[144:159], v[76:79], v[136:139], v[144:159]
    v_exp_f32 v114, v114
    v_exp_f32 v115, v115
    v_exp_f32 v116, v116
    v_exp_f32 v117, v117
    v_mfma_f32_32x32x16_bf16 v[128:143], v[28:31], v[160:163], 0
    v_exp_f32 v118, v118
    v_exp_f32 v119, v119
    v_cvt_pk_bf16_f32 v112, v112, v113
    v_cvt_pk_bf16_f32 v113, v114, v115
    v_cvt_pk_bf16_f32 v114, v116, v117
    v_cvt_pk_bf16_f32 v115, v118, v119
    v_exp_f32 v120, v120
    v_mfma_f32_32x32x8_bf16 v[128:143], v[44:45], v[166:167], v[128:143]
    v_exp_f32 v121, v121
    v_exp_f32 v122, v122
    v_exp_f32 v123, v123
    v_exp_f32 v124, v124
    v_mfma_f32_32x32x16_bf16 v[144:159], v[80:83], v[112:115], v[144:159]
    v_exp_f32 v125, v125
    v_exp_f32 v126, v126
    v_exp_f32 v127, v127
    v_cvt_pk_bf16_f32 v120, v120, v121
    v_cvt_pk_bf16_f32 v121, v122, v123
    v_cvt_pk_bf16_f32 v122, v124, v125
    v_cvt_pk_bf16_f32 v123, v126, v127
    v_exp_f32 v128, v128
    v_exp_f32 v129, v129
    v_mfma_f32_32x32x16_bf16 v[144:159], v[84:87], v[120:123], v[144:159]
    v_exp_f32 v130, v130
    v_exp_f32 v131, v131
    v_exp_f32 v132, v132
    v_exp_f32 v133, v133
    v_mfma_f32_32x32x16_bf16 v[112:127], v[32:35], v[160:163], 0
    v_exp_f32 v134, v134
    v_exp_f32 v135, v135
    v_cvt_pk_bf16_f32 v128, v128, v129
    v_cvt_pk_bf16_f32 v129, v130, v131
    v_cvt_pk_bf16_f32 v130, v132, v133
    v_cvt_pk_bf16_f32 v131, v134, v135
    v_exp_f32 v136, v136
    v_mfma_f32_32x32x8_bf16 v[112:127], v[46:47], v[164:165], v[112:127]
    v_exp_f32 v137, v137
    v_exp_f32 v138, v138
    v_exp_f32 v139, v139
    v_exp_f32 v140, v140
    v_mfma_f32_32x32x16_bf16 v[144:159], v[88:91], v[128:131], v[144:159]
    v_exp_f32 v141, v141
    v_exp_f32 v142, v142
    v_exp_f32 v143, v143
    v_cvt_pk_bf16_f32 v136, v136, v137
    v_cvt_pk_bf16_f32 v137, v138, v139
    v_cvt_pk_bf16_f32 v138, v140, v141
    v_cvt_pk_bf16_f32 v139, v142, v143
    v_exp_f32 v112, v112
    v_exp_f32 v113, v113
    v_mfma_f32_32x32x16_bf16 v[144:159], v[92:95], v[136:139], v[144:159]
    v_exp_f32 v114, v114
    v_exp_f32 v115, v115
    v_exp_f32 v116, v116
    v_exp_f32 v117, v117
    v_mfma_f32_32x32x16_bf16 v[128:143], v[36:39], v[160:163], 0
    v_exp_f32 v118, v118
    ds_read_b128 v[160:163], v5 offset:0
    v_exp_f32 v119, v119
    v_cvt_pk_bf16_f32 v112, v112, v113
    v_cvt_pk_bf16_f32 v113, v114, v115
    v_cvt_pk_bf16_f32 v114, v116, v117
    v_cvt_pk_bf16_f32 v115, v118, v119
    v_exp_f32 v120, v120
    v_mfma_f32_32x32x8_bf16 v[128:143], v[46:47], v[166:167], v[128:143]
    v_exp_f32 v121, v121
    ds_read_b128 v[164:167], v5 offset:1024
    ds_read_b32 v0, v7
    v_exp_f32 v122, v122
    v_exp_f32 v123, v123
    v_exp_f32 v124, v124
    v_mfma_f32_32x32x16_bf16 v[144:159], v[96:99], v[112:115], v[144:159]
    v_exp_f32 v125, v125
    v_exp_f32 v126, v126
    v_exp_f32 v127, v127
    v_cvt_pk_bf16_f32 v120, v120, v121
    v_cvt_pk_bf16_f32 v121, v122, v123
    v_cvt_pk_bf16_f32 v122, v124, v125
    v_cvt_pk_bf16_f32 v123, v126, v127
    v_exp_f32 v128, v128
    v_exp_f32 v129, v129
    v_mfma_f32_32x32x16_bf16 v[144:159], v[100:103], v[120:123], v[144:159]
    v_exp_f32 v130, v130
    v_exp_f32 v131, v131
    s_setprio 0
    v_exp_f32 v132, v132
    v_exp_f32 v133, v133
    s_waitcnt lgkmcnt(0)
    v_mfma_f32_32x32x16_bf16 v[112:127], v[8:11], v[160:163], 0
    v_exp_f32 v134, v134
    v_readfirstlane_b32 s45, v0
    v_exp_f32 v135, v135
    v_cvt_pk_bf16_f32 v128, v128, v129
    v_cvt_pk_bf16_f32 v129, v130, v131
    v_cvt_pk_bf16_f32 v130, v132, v133
    v_cvt_pk_bf16_f32 v131, v134, v135
    v_exp_f32 v136, v136
    s_cmp_lt_u32 s45, s65
    s_cbranch_scc1 K2_fwlb
K2_folb:
    v_mfma_f32_32x32x8_bf16 v[112:127], v[40:41], v[164:165], v[112:127]
    v_exp_f32 v137, v137
    v_exp_f32 v138, v138
    v_exp_f32 v139, v139
    v_exp_f32 v140, v140
    v_mfma_f32_32x32x16_bf16 v[144:159], v[104:107], v[128:131], v[144:159]
    v_exp_f32 v141, v141
    s_add_u32 s52, s52, 1
    s_cmp_lt_u32 s52, 8
    v_exp_f32 v142, v142
    v_exp_f32 v143, v143
    v_cvt_pk_bf16_f32 v136, v136, v137
    v_cvt_pk_bf16_f32 v137, v138, v139
    v_cvt_pk_bf16_f32 v138, v140, v141
    v_cvt_pk_bf16_f32 v139, v142, v143
    s_cbranch_scc1 K2_loopb
K2_ran:
    s_nop 0
    v_mfma_f32_32x32x16_bf16 v[144:159], v[108:111], v[136:139], v[144:159]
    s_nop 11
    v_mov_b32 v155, s52
    ds_write_b128 v6, v[144:147]
    ds_write_b128 v6, v[148:151] offset:1024
    s_mov_b64 exec, s[58:59]
    ds_write_b128 v6, v[152:155] offset:2048
    s_mov_b64 exec, -1
    v_mov_b32 v112, 110368
    v_mov_b32 v113, 1
    s_mov_b64 exec, 1
    ds_add_rtn_u32 v114, v112, v113
    s_mov_b64 exec, -1
    s_waitcnt lgkmcnt(0)
    v_readfirstlane_b32 s45, v114
    s_cmp_lg_u32 s45, 7
    s_cbranch_scc1 K2_end
    s_mov_b32 s52, 7
    s_call_b64 s[98:99], K2_red
    s_branch K2_end
K2_fwla:
    s_sleep 2
    ds_read_b32 v0, v7
    s_waitcnt lgkmcnt(0)
    v_readfirstlane_b32 s45, v0
    s_cmp_lt_u32 s45, s65
    s_cbranch_scc1 K2_fwla
    s_branch K2_fola
K2_fwlb:
    s_sleep 2
    ds_read_b32 v0, v7
    s_waitcnt lgkmcnt(0)
    v_readfirstlane_b32 s45, v0
    s_cmp_lt_u32 s45, s65
    s_cbranch_scc1 K2_fwlb
    s_branch K2_folb
K2_helper:
    s_mov_b32 s36, s92
    s_mov_b32 s37, s93
    s_mov_b32 s38, 0x480000
    s_mov_b32 s39, 0x00020000
    s_and_b32 s60, s40, 1
    v_and_b32 v0, 7, v1
    v_mul_u32_u24 v0, 1168, v0
    v_and_b32 v2, 48, v1
    v_add_u32 v0, v0, v2
    v_add_u32 v0, 100864, v0
    v_add_u32 v2, 98304, v2
    v_and_b32 v4, 8, v1
    v_cmp_ne_u32 vcc, 0, v4
    s_nop 1
    v_cndmask_b32 v0, v0, v2, vcc
    s_setprio 3
    s_cmp_ge_u32 s40, 10
    s_cbranch_scc1 K2_opw
    s_cmp_eq_u32 s60, 0
    s_cselect_b32 s4, s8, s10
    s_cselect_b32 s5, s9, s11
    s_mov_b32 s6, 8388608
    s_mov_b32 s7, 0x00020000
    s_and_b32 s62, s2, 7
    s_lshr_b32 s65, s2, 3
    s_and_b32 s63, s65, 15
    s_lshr_b32 s61, s2, 7
    s_lshl_b32 s68, s62, 1
    s_lshr_b32 s45, s63, 3
    s_add_u32 s68, s68, s45
    s_mov_b32 s20, s68
    s_sub_u32 s45, 15, s63
    s_min_u32 s21, s45, s63
    s_mov_b32 s70, 0
    s_lshl_b32 s71, s61, 4
    s_add_u32 s71, s71, s21
    s_lshl_b32 s71, s71, 7
    s_add_u32 s71, s71, 8585216
    s_lshl_b32 s29, s61, 3
    s_add_u32 s29, s29, s62
    s_lshl_b32 s29, s29, 7
    s_add_u32 s29, s29, 8589312
    s_mov_b32 s57, s62
    v_and_b32 v10, 31, v1
    v_lshrrev_b32 v11, 5, v1
    v_min_u32 v2, 18, v10
    v_lshlrev_b32 v4, 4, v2
    v_mul_u32_u24 v5, 304, v11
    v_add_u32 v9, v4, v5
    v_subrev_u32 v4, 6, v10
    v_cmp_lt_u32 vcc, 15, v10
    s_nop 1
    v_cndmask_b32 v4, v10, v4, vcc
    v_min_u32 v4, 18, v4
    v_lshlrev_b32 v7, 10, v4
    v_lshlrev_b32 v5, 9, v11
    v_add_u32 v7, v7, v5
    v_sub_u32 v4, 18, v2
    v_lshlrev_b32 v4, 4, v4
    v_mul_u32_u24 v5, 304, v11
    v_add_u32 v15, v4, v5
    v_mov_b32 v6, 0x40000000
    v_cmp_lt_u32 vcc, 18, v10
    s_nop 1
    v_cndmask_b32 v8, v9, v6, vcc
    v_cndmask_b32 v15, v15, v6, vcc
    v_mov_b32 v9, v8
    s_lshl_b32 s45, s57, 6
    s_add_u32 s45, s45, s61
    v_lshlrev_b32 v4, 1, v10
    v_add_u32 v4, s45, v4
    v_lshlrev_b32 v4, 12, v4
    v_lshlrev_b32 v5, 5, v11
    v_add_u32 v12, v4, v5
    v_mov_b32 v2, 110364
K2_kvw:
    s_sleep 4
    ds_read_b32 v4, v2
    s_waitcnt lgkmcnt(0)
    v_readfirstlane_b32 s46, v4
    s_cmp_lt_u32 s46, 4
    s_cbranch_scc1 K2_kvw
K2_bs:
    s_lshl_b32 s65, s60, 1
    s_add_u32 s65, s65, s61
    s_mul_i32 s30, s65, 17
    s_add_u32 s30, s30, s68
    s_mul_i32 s30, s30, 19456
    s_add_u32 s30, s30, 4980736
    s_add_u32 s67, s30, 19456
    s_lshl_b32 s32, s60, 3
    s_add_u32 s32, s32, s21
    s_mul_i32 s32, s32, 11552
    s_add_u32 s32, s32, 9175040
    buffer_load_dwordx4 v[64:67], v7, s[24:27], s67 offen
    buffer_load_dwordx4 v[72:75], v3, s[24:27], s30 offen offset:0
    buffer_load_dwordx4 v[76:79], v9, s[24:27], s32 offen offset:0
    buffer_load_dwordx4 v[80:83], v3, s[24:27], s30 offen offset:1024
    buffer_load_dwordx4 v[84:87], v9, s[24:27], s32 offen offset:608
    buffer_load_dwordx4 v[88:91], v3, s[24:27], s30 offen offset:2048
    buffer_load_dwordx4 v[92:95], v9, s[24:27], s32 offen offset:1216
    buffer_load_dwordx4 v[96:99], v3, s[24:27], s30 offen offset:3072
    buffer_load_dwordx4 v[100:103], v9, s[24:27], s32 offen offset:1824
    s_add_u32 s30, s30, 4096
    buffer_load_dwordx4 v[104:107], v3, s[24:27], s30 offen offset:0
    buffer_load_dwordx4 v[108:111], v9, s[24:27], s32 offen offset:2432
    buffer_load_dwordx4 v[112:115], v3, s[24:27], s30 offen offset:1024
    buffer_load_dwordx4 v[116:119], v9, s[24:27], s32 offen offset:3040
    s_add_u32 s32, s32, 3648
    buffer_load_dwordx4 v[120:123], v3, s[24:27], s30 offen offset:2048
    buffer_load_dwordx4 v[124:127], v9, s[24:27], s32 offen offset:0
    buffer_load_dwordx4 v[128:131], v3, s[24:27], s30 offen offset:3072
    buffer_load_dwordx4 v[132:135], v9, s[24:27], s32 offen offset:608
    s_add_u32 s30, s30, 4096
    buffer_load_dwordx4 v[136:139], v3, s[24:27], s30 offen offset:0
    buffer_load_dwordx4 v[140:143], v9, s[24:27], s32 offen offset:1216
    buffer_load_dwordx4 v[144:147], v3, s[24:27], s30 offen offset:1024
    buffer_load_dwordx4 v[148:151], v9, s[24:27], s32 offen offset:1824
    buffer_load_dwordx4 v[152:155], v3, s[24:27], s30 offen offset:2048
    buffer_load_dwordx4 v[156:159], v9, s[24:27], s32 offen offset:2432
    buffer_load_dwordx4 v[160:163], v3, s[24:27], s30 offen offset:3072
    buffer_load_dwordx4 v[164:167], v9, s[24:27], s32 offen offset:3040
    s_lshl_b32 s65, s65, 4
    s_add_u32 s31, s65, 15
    s_sub_u32 s31, s31, s21
    s_add_u32 s65, s65, s21
    s_lshl_b32 s67, s68, 1
    s_mul_i32 s65, s65, 34
    s_add_u32 s65, s65, s67
    s_mul_i32 s65, s65, 608
    s_add_u32 s65, s65, 6356992
    s_mul_i32 s31, s31, 34
    s_add_u32 s31, s31, s67
    s_mul_i32 s31, s31, 608
    s_add_u32 s31, s31, 6356992
    s_cmp_eq_u32 s60, 0
    s_cselect_b32 s22, 1.0, -1.0
    s_mov_b32 s96, 1
    s_mov_b32 s97, 1
    v_mov_b32 v48, 0
    v_mov_b32 v49, 0
    v_mov_b32 v50, 0
    v_mov_b32 v51, 0
    v_mov_b32 v52, 0
    v_mov_b32 v53, 0
    v_mov_b32 v54, 0
    v_mov_b32 v55, 0
    v_mov_b32 v56, 0
    v_mov_b32 v57, 0
    v_mov_b32 v58, 0
    v_mov_b32 v59, 0
    v_mov_b32 v60, 0
    v_mov_b32 v61, 0
    v_mov_b32 v62, 0
    v_mov_b32 v63, 0
    s_waitcnt vmcnt(22)
    v_mfma_f32_32x32x16_bf16 v[16:31], v[72:75], v[76:79], 0
    s_cmp_lg_u32 s68, 15
    s_cbranch_scc1 K2_sx0
    v_cndmask_b32 v68, 0, v64, s[96:97]
    v_cndmask_b32 v69, 0, v65, s[96:97]
    v_cndmask_b32 v70, 0, v66, s[96:97]
    v_cndmask_b32 v71, 0, v67, s[96:97]
    s_lshl_b64 s[96:97], s[96:97], 1
    s_nop 0
    v_mfma_f32_32x32x16_bf16 v[48:63], v[68:71], v[76:79], v[48:63]
K2_sx0:
    s_add_u32 s30, s30, 4096
    s_add_u32 s32, s32, 3648
    buffer_load_dwordx4 v[72:75], v3, s[24:27], s30 offen offset:0
    buffer_load_dwordx4 v[76:79], v9, s[24:27], s32 offen offset:0
    s_waitcnt vmcnt(22)
    v_mfma_f32_32x32x16_bf16 v[16:31], v[80:83], v[84:87], v[16:31]
    s_cmp_lg_u32 s68, 15
    s_cbranch_scc1 K2_sx1
    v_cndmask_b32 v68, 0, v64, s[96:97]
    v_cndmask_b32 v69, 0, v65, s[96:97]
    v_cndmask_b32 v70, 0, v66, s[96:97]
    v_cndmask_b32 v71, 0, v67, s[96:97]
    s_lshl_b64 s[96:97], s[96:97], 1
    s_nop 0
    v_mfma_f32_32x32x16_bf16 v[48:63], v[68:71], v[84:87], v[48:63]
K2_sx1:
    buffer_load_dwordx4 v[80:83], v3, s[24:27], s30 offen offset:1024
    buffer_load_dwordx4 v[84:87], v9, s[24:27], s32 offen offset:608
    s_waitcnt vmcnt(22)
    v_mfma_f32_32x32x16_bf16 v[16:31], v[88:91], v[92:95], v[16:31]
    s_cmp_lg_u32 s68, 15
    s_cbranch_scc1 K2_sx2
    v_cndmask_b32 v68, 0, v64, s[96:97]
    v_cndmask_b32 v69, 0, v65, s[96:97]
    v_cndmask_b32 v70, 0, v66, s[96:97]
    v_cndmask_b32 v71, 0, v67, s[96:97]
    s_lshl_b64 s[96:97], s[96:97], 1
    s_nop 0
    v_mfma_f32_32x32x16_bf16 v[48:63], v[68:71], v[92:95], v[48:63]
K2_sx2:
    buffer_load_dwordx4 v[88:91], v3, s[24:27], s30 offen offset:2048
    buffer_load_dwordx4 v[92:95], v9, s[24:27], s32 offen offset:1216
    s_waitcnt vmcnt(22)
    v_mfma_f32_32x32x16_bf16 v[16:31], v[96:99], v[100:103], v[16:31]
    s_cmp_lg_u32 s68, 15
    s_cbranch_scc1 K2_sx3
    v_cndmask_b32 v68, 0, v64, s[96:97]
    v_cndmask_b32 v69, 0, v65, s[96:97]
    v_cndmask_b32 v70, 0, v66, s[96:97]
    v_cndmask_b32 v71, 0, v67, s[96:97]
    s_lshl_b64 s[96:97], s[96:97], 1
    s_nop 0
    v_mfma_f32_32x32x16_bf16 v[48:63], v[68:71], v[100:103], v[48:63]
K2_sx3:
    buffer_load_dwordx4 v[96:99], v3, s[24:27], s30 offen offset:3072
    buffer_load_dwordx4 v[100:103], v9, s[24:27], s32 offen offset:1824
    s_waitcnt vmcnt(22)
    v_mfma_f32_32x32x16_bf16 v[16:31], v[104:107], v[108:111], v[16:31]
    s_cmp_lg_u32 s68, 15
    s_cbranch_scc1 K2_sx4
    v_cndmask_b32 v68, 0, v64, s[96:97]
    v_cndmask_b32 v69, 0, v65, s[96:97]
    v_cndmask_b32 v70, 0, v66, s[96:97]
    v_cndmask_b32 v71, 0, v67, s[96:97]
    s_lshl_b64 s[96:97], s[96:97], 1
    s_nop 0
    v_mfma_f32_32x32x16_bf16 v[48:63], v[68:71], v[108:111], v[48:63]
K2_sx4:
    s_add_u32 s30, s30, 4096
    buffer_load_dwordx4 v[104:107], v3, s[24:27], s30 offen offset:0
    buffer_load_dwordx4 v[108:111], v9, s[24:27], s32 offen offset:2432
    s_waitcnt vmcnt(22)
    v_mfma_f32_32x32x16_bf16 v[16:31], v[112:115], v[116:119], v[16:31]
    s_cmp_lg_u32 s68, 15
    s_cbranch_scc1 K2_sx5
    v_cndmask_b32 v68, 0, v64, s[96:97]
    v_cndmask_b32 v69, 0, v65, s[96:97]
    v_cndmask_b32 v70, 0, v66, s[96:97]
    v_cndmask_b32 v71, 0, v67, s[96:97]
    s_lshl_b64 s[96:97], s[96:97], 1
    s_nop 0
    v_mfma_f32_32x32x16_bf16 v[48:63], v[68:71], v[116:119], v[48:63]
K2_sx5:
    buffer_load_dwordx4 v[112:115], v3, s[24:27], s30 offen offset:1024
    buffer_load_dwordx4 v[116:119], v9, s[24:27], s32 offen offset:3040
    s_waitcnt vmcnt(22)
    v_mfma_f32_32x32x16_bf16 v[16:31], v[120:123], v[124:127], v[16:31]
    s_cmp_lg_u32 s68, 15
    s_cbranch_scc1 K2_sx6
    v_cndmask_b32 v68, 0, v64, s[96:97]
    v_cndmask_b32 v69, 0, v65, s[96:97]
    v_cndmask_b32 v70, 0, v66, s[96:97]
    v_cndmask_b32 v71, 0, v67, s[96:97]
    s_lshl_b64 s[96:97], s[96:97], 1
    s_nop 0
    v_mfma_f32_32x32x16_bf16 v[48:63], v[68:71], v[124:127], v[48:63]
K2_sx6:
    s_add_u32 s32, s32, 3648
    buffer_load_dwordx4 v[120:123], v3, s[24:27], s30 offen offset:2048
    buffer_load_dwordx4 v[124:127], v9, s[24:27], s32 offen offset:0
    s_waitcnt vmcnt(22)
    v_mfma_f32_32x32x16_bf16 v[16:31], v[128:131], v[132:135], v[16:31]
    s_cmp_lg_u32 s68, 15
    s_cbranch_scc1 K2_sx7
    v_cndmask_b32 v68, 0, v64, s[96:97]
    v_cndmask_b32 v69, 0, v65, s[96:97]
    v_cndmask_b32 v70, 0, v66, s[96:97]
    v_cndmask_b32 v71, 0, v67, s[96:97]
    s_lshl_b64 s[96:97], s[96:97], 1
    s_nop 0
    v_mfma_f32_32x32x16_bf16 v[48:63], v[68:71], v[132:135], v[48:63]
K2_sx7:
    s_waitcnt vmcnt(20)
    v_mfma_f32_32x32x16_bf16 v[16:31], v[136:139], v[140:143], v[16:31]
    s_cmp_lg_u32 s68, 15
    s_cbranch_scc1 K2_sx8
    v_cndmask_b32 v68, 0, v64, s[96:97]
    v_cndmask_b32 v69, 0, v65, s[96:97]
    v_cndmask_b32 v70, 0, v66, s[96:97]
    v_cndmask_b32 v71, 0, v67, s[96:97]
    s_lshl_b64 s[96:97], s[96:97], 1
    s_nop 0
    v_mfma_f32_32x32x16_bf16 v[48:63], v[68:71], v[140:143], v[48:63]
K2_sx8:
    s_waitcnt vmcnt(18)
    v_mfma_f32_32x32x16_bf16 v[16:31], v[144:147], v[148:151], v[16:31]
    s_cmp_lg_u32 s68, 15
    s_cbranch_scc1 K2_sx9
    v_cndmask_b32 v68, 0, v64, s[96:97]
    v_cndmask_b32 v69, 0, v65, s[96:97]
    v_cndmask_b32 v70, 0, v66, s[96:97]
    v_cndmask_b32 v71, 0, v67, s[96:97]
    s_lshl_b64 s[96:97], s[96:97], 7
    s_nop 0
    v_mfma_f32_32x32x16_bf16 v[48:63], v[68:71], v[148:151], v[48:63]
K2_sx9:
    s_waitcnt vmcnt(16)
    v_mfma_f32_32x32x16_bf16 v[32:47], v[152:155], v[156:159], 0
    s_cmp_lg_u32 s68, 15
    s_cbranch_scc1 K2_sx10
    v_cndmask_b32 v68, 0, v64, s[96:97]
    v_cndmask_b32 v69, 0, v65, s[96:97]
    v_cndmask_b32 v70, 0, v66, s[96:97]
    v_cndmask_b32 v71, 0, v67, s[96:97]
    s_lshl_b64 s[96:97], s[96:97], 1
    s_nop 0
    v_mfma_f32_32x32x16_bf16 v[48:63], v[68:71], v[156:159], v[48:63]
K2_sx10:
    s_waitcnt vmcnt(14)
    v_mfma_f32_32x32x16_bf16 v[32:47], v[160:163], v[164:167], v[32:47]
    s_cmp_lg_u32 s68, 15
    s_cbranch_scc1 K2_sx11
    v_cndmask_b32 v68, 0, v64, s[96:97]
    v_cndmask_b32 v69, 0, v65, s[96:97]
    v_cndmask_b32 v70, 0, v66, s[96:97]
    v_cndmask_b32 v71, 0, v67, s[96:97]
    s_lshl_b64 s[96:97], s[96:97], 1
    s_nop 0
    v_mfma_f32_32x32x16_bf16 v[48:63], v[68:71], v[164:167], v[48:63]
K2_sx11:
    s_waitcnt vmcnt(12)
    v_mfma_f32_32x32x16_bf16 v[32:47], v[72:75], v[76:79], v[32:47]
    s_cmp_lg_u32 s68, 15
    s_cbranch_scc1 K2_sx12
    v_cndmask_b32 v68, 0, v64, s[96:97]
    v_cndmask_b32 v69, 0, v65, s[96:97]
    v_cndmask_b32 v70, 0, v66, s[96:97]
    v_cndmask_b32 v71, 0, v67, s[96:97]
    s_lshl_b64 s[96:97], s[96:97], 1
    s_nop 0
    v_mfma_f32_32x32x16_bf16 v[48:63], v[68:71], v[76:79], v[48:63]
K2_sx12:
    s_waitcnt vmcnt(10)
    v_mfma_f32_32x32x16_bf16 v[32:47], v[80:83], v[84:87], v[32:47]
    s_cmp_lg_u32 s68, 15
    s_cbranch_scc1 K2_sx13
    v_cndmask_b32 v68, 0, v64, s[96:97]
    v_cndmask_b32 v69, 0, v65, s[96:97]
    v_cndmask_b32 v70, 0, v66, s[96:97]
    v_cndmask_b32 v71, 0, v67, s[96:97]
    s_lshl_b64 s[96:97], s[96:97], 1
    s_nop 0
    v_mfma_f32_32x32x16_bf16 v[48:63], v[68:71], v[84:87], v[48:63]
K2_sx13:
    s_waitcnt vmcnt(8)
    v_mfma_f32_32x32x16_bf16 v[32:47], v[88:91], v[92:95], v[32:47]
    s_cmp_lg_u32 s68, 15
    s_cbranch_scc1 K2_sx14
    v_cndmask_b32 v68, 0, v64, s[96:97]
    v_cndmask_b32 v69, 0, v65, s[96:97]
    v_cndmask_b32 v70, 0, v66, s[96:97]
    v_cndmask_b32 v71, 0, v67, s[96:97]
    s_lshl_b64 s[96:97], s[96:97], 1
    s_nop 0
    v_mfma_f32_32x32x16_bf16 v[48:63], v[68:71], v[92:95], v[48:63]
K2_sx14:
    s_waitcnt vmcnt(6)
    v_mfma_f32_32x32x16_bf16 v[32:47], v[96:99], v[100:103], v[32:47]
    s_cmp_lg_u32 s68, 15
    s_cbranch_scc1 K2_sx15
    v_cndmask_b32 v68, 0, v64, s[96:97]
    v_cndmask_b32 v69, 0, v65, s[96:97]
    v_cndmask_b32 v70, 0, v66, s[96:97]
    v_cndmask_b32 v71, 0, v67, s[96:97]
    s_lshl_b64 s[96:97], s[96:97], 1
    s_nop 0
    v_mfma_f32_32x32x16_bf16 v[48:63], v[68:71], v[100:103], v[48:63]
K2_sx15:
    s_waitcnt vmcnt(4)
    v_mfma_f32_32x32x16_bf16 v[32:47], v[104:107], v[108:111], v[32:47]
    s_cmp_lg_u32 s68, 15
    s_cbranch_scc1 K2_sx16
    v_cndmask_b32 v68, 0, v64, s[96:97]
    v_cndmask_b32 v69, 0, v65, s[96:97]
    v_cndmask_b32 v70, 0, v66, s[96:97]
    v_cndmask_b32 v71, 0, v67, s[96:97]
    s_lshl_b64 s[96:97], s[96:97], 1
    s_nop 0
    v_mfma_f32_32x32x16_bf16 v[48:63], v[68:71], v[108:111], v[48:63]
K2_sx16:
    s_waitcnt vmcnt(2)
    v_mfma_f32_32x32x16_bf16 v[32:47], v[112:115], v[116:119], v[32:47]
    s_cmp_lg_u32 s68, 15
    s_cbranch_scc1 K2_sx17
    v_cndmask_b32 v68, 0, v64, s[96:97]
    v_cndmask_b32 v69, 0, v65, s[96:97]
    v_cndmask_b32 v70, 0, v66, s[96:97]
    v_cndmask_b32 v71, 0, v67, s[96:97]
    s_lshl_b64 s[96:97], s[96:97], 1
    s_nop 0
    v_mfma_f32_32x32x16_bf16 v[48:63], v[68:71], v[116:119], v[48:63]
K2_sx17:
    s_waitcnt vmcnt(0)
    v_mfma_f32_32x32x16_bf16 v[32:47], v[120:123], v[124:127], v[32:47]
    s_cmp_lg_u32 s68, 15
    s_cbranch_scc1 K2_sx18
    v_cndmask_b32 v68, 0, v64, s[96:97]
    v_cndmask_b32 v69, 0, v65, s[96:97]
    v_cndmask_b32 v70, 0, v66, s[96:97]
    v_cndmask_b32 v71, 0, v67, s[96:97]
    s_lshl_b64 s[96:97], s[96:97], 1
    s_nop 0
    v_mfma_f32_32x32x16_bf16 v[48:63], v[68:71], v[124:127], v[48:63]
K2_sx18:
    s_lshl_b32 s33, s63, 6
    buffer_load_dwordx4 v[136:139], v12, s[4:7], s33 offen
    buffer_load_dwordx4 v[140:143], v12, s[4:7], s33 offen offset:16
    buffer_load_dwordx4 v[144:147], v12, s[4:7], 0 offen offset:1024
    s_nop 5
    v_sub_f32 v88, v16, v32
    v_add_f32 v16, v16, v32
    v_mul_f32 v32, s22, v88
    v_sub_f32 v89, v17, v33
    v_add_f32 v17, v17, v33
    v_mul_f32 v33, s22, v89
    v_sub_f32 v90, v18, v34
    v_add_f32 v18, v18, v34
    v_mul_f32 v34, s22, v90
    v_sub_f32 v91, v19, v35
    v_add_f32 v19, v19, v35
    v_mul_f32 v35, s22, v91
    v_sub_f32 v92, v20, v36
    v_add_f32 v20, v20, v36
    v_mul_f32 v36, s22, v92
    v_sub_f32 v93, v21, v37
    v_add_f32 v21, v21, v37
    v_mul_f32 v37, s22, v93
    v_sub_f32 v94, v22, v38
    v_add_f32 v22, v22, v38
    v_mul_f32 v38, s22, v94
    v_sub_f32 v95, v23, v39
    v_add_f32 v23, v23, v39
    v_mul_f32 v39, s22, v95
    v_sub_f32 v96, v24, v40
    v_add_f32 v24, v24, v40
    v_mul_f32 v40, s22, v96
    v_sub_f32 v97, v25, v41
    v_add_f32 v25, v25, v41
    v_mul_f32 v41, s22, v97
    v_sub_f32 v98, v26, v42
    v_add_f32 v26, v26, v42
    v_mul_f32 v42, s22, v98
    v_sub_f32 v99, v27, v43
    v_add_f32 v27, v27, v43
    v_mul_f32 v43, s22, v99
    v_sub_f32 v100, v28, v44
    v_add_f32 v28, v28, v44
    v_mul_f32 v44, s22, v100
    v_sub_f32 v101, v29, v45
    v_add_f32 v29, v29, v45
    v_mul_f32 v45, s22, v101
    v_sub_f32 v102, v30, v46
    v_add_f32 v30, v30, v46
    v_mul_f32 v46, s22, v102
    v_sub_f32 v103, v31, v47
    v_add_f32 v31, v31, v47
    v_mul_f32 v47, s22, v103
    v_cvt_pk_bf16_f32 v72, v16, v17
    v_cvt_pk_bf16_f32 v73, v18, v19
    v_cvt_pk_bf16_f32 v74, v20, v21
    v_cvt_pk_bf16_f32 v75, v22, v23
    v_cvt_pk_bf16_f32 v76, v24, v25
    v_cvt_pk_bf16_f32 v77, v26, v27
    v_cvt_pk_bf16_f32 v78, v28, v29
    v_cvt_pk_bf16_f32 v79, v30, v31
    v_permlane32_swap_b32 v72, v74
    v_permlane32_swap_b32 v73, v75
    v_permlane32_swap_b32 v76, v78
    v_permlane32_swap_b32 v77, v79
    buffer_store_dwordx4 v[72:75], v8, s[24:27], s65 offen sc1
    buffer_store_dwordx4 v[76:79], v8, s[24:27], s65 offen offset:608 sc1
    v_cvt_pk_bf16_f32 v80, v32, v33
    v_cvt_pk_bf16_f32 v81, v34, v35
    v_cvt_pk_bf16_f32 v82, v36, v37
    v_cvt_pk_bf16_f32 v83, v38, v39
    v_cvt_pk_bf16_f32 v84, v40, v41
    v_cvt_pk_bf16_f32 v85, v42, v43
    v_cvt_pk_bf16_f32 v86, v44, v45
    v_cvt_pk_bf16_f32 v87, v46, v47
    v_permlane32_swap_b32 v80, v82
    v_permlane32_swap_b32 v81, v83
    v_permlane32_swap_b32 v84, v86
    v_permlane32_swap_b32 v85, v87
    buffer_store_dwordx4 v[80:83], v15, s[24:27], s31 offen sc1
    buffer_store_dwordx4 v[84:87], v15, s[24:27], s31 offen offset:608 sc1
    s_cmp_lg_u32 s68, 15
    s_cbranch_scc1 K2_bsf
    v_add_f32 v48, v48, v49
    v_add_f32 v56, v56, v57
    v_add_f32 v48, v48, v50
    v_add_f32 v56, v56, v58
    v_add_f32 v48, v48, v51
    v_add_f32 v56, v56, v59
    v_add_f32 v48, v48, v52
    v_add_f32 v56, v56, v60
    v_add_f32 v48, v48, v53
    v_add_f32 v56, v56, v61
    v_add_f32 v48, v48, v54
    v_add_f32 v56, v56, v62
    v_add_f32 v48, v48, v55
    v_add_f32 v56, v56, v63
    v_sub_f32 v50, v48, v56
    v_add_f32 v48, v48, v56
    v_mul_f32 v50, s22, v50
    v_mov_b32 v49, v48
    v_mov_b32 v51, v50
    v_mov_b32 v69, 0
    v_mov_b32 v70, 0
    v_permlane32_swap_b32 v48, v49
    v_permlane32_swap_b32 v50, v51
    v_mov_b32 v71, 0
    v_add_f32 v48, v48, v49
    v_add_f32 v50, v50, v51
    v_cvt_pk_bf16_f32 v68, v48, v69
    v_cvt_pk_bf16_f32 v52, v50, v69
    v_cndmask_b32 v68, 0, v68, s[58:59]
    v_cndmask_b32 v52, 0, v52, s[58:59]
    v_mov_b32 v53, 0
    v_mov_b32 v54, 0
    v_mov_b32 v55, 0
    buffer_store_dwordx4 v[68:71], v8, s[24:27], s65 offen offset:1216 sc1
    buffer_store_dwordx4 v[52:55], v15, s[24:27], s31 offen offset:1216 sc1
K2_bsf:
    s_lshl_b32 s30, s60, 1
    s_add_u32 s30, s30, s61
    s_lshl_b32 s30, s30, 3
    s_add_u32 s30, s30, s57
    s_mul_i32 s30, s30, 33792
    s_add_u32 s30, s30, 2621440
    s_waitcnt vmcnt(0)
    s_cmp_eq_u32 s70, 0
    s_cbranch_scc1 K2_bsd
    s_add_u32 s68, s68, 1
    s_cmp_le_u32 s68, 15
    s_cbranch_scc1 K2_bs
    s_mov_b32 s45, 0
    s_mov_b32 s46, s30
K2_cfl:
    buffer_load_dwordx4 v[136:139], v12, s[4:7], s45 offen
    buffer_load_dwordx4 v[140:143], v12, s[4:7], s45 offen offset:16
    s_add_u32 s67, s46, 16384
    s_waitcnt vmcnt(0)
    s_mov_b32 s96, 0x05040100
    s_mov_b32 s97, 0x07060302
    v_perm_b32 v148, v137, v136, s96
    v_perm_b32 v152, v137, v136, s97
    v_perm_b32 v149, v139, v138, s96
    v_perm_b32 v153, v139, v138, s97
    v_perm_b32 v150, v141, v140, s96
    v_perm_b32 v154, v141, v140, s97
    v_perm_b32 v151, v143, v142, s96
    v_perm_b32 v155, v143, v142, s97
    buffer_store_dwordx4 v[148:151], v3, s[24:27], s46 offen sc1
    buffer_store_dwordx4 v[152:155], v3, s[24:27], s67 offen sc1
    s_waitcnt vmcnt(0)
    s_add_u32 s45, s45, 64
    s_add_u32 s46, s46, 1024
    s_cmp_lt_u32 s45, 1024
    s_cbranch_scc1 K2_cfl
    v_mov_b32 v2, 110360
    v_mov_b32 v4, 1
    s_mov_b64 exec, 1
    ds_add_u32 v2, v4
K2_bsm2:
    ds_read_b32 v5, v2
    s_waitcnt lgkmcnt(0)
    v_readfirstlane_b32 s46, v5
    s_cmp_ge_u32 s46, 2
    s_cbranch_scc1 K2_bb
    s_sleep 2
    s_branch K2_bsm2
K2_bsd:
    s_mov_b32 s96, 0x05040100
    s_mov_b32 s97, 0x07060302
    v_perm_b32 v148, v137, v136, s96
    v_perm_b32 v152, v137, v136, s97
    v_perm_b32 v149, v139, v138, s96
    v_perm_b32 v153, v139, v138, s97
    v_perm_b32 v150, v141, v140, s96
    v_perm_b32 v154, v141, v140, s97
    v_perm_b32 v151, v143, v142, s96
    v_perm_b32 v155, v143, v142, s97
    s_lshl_b32 s45, s63, 10
    s_add_u32 s45, s45, s30
    s_add_u32 s46, s45, 16384
    s_add_u32 s67, s30, 32768
    buffer_store_dwordx4 v[148:151], v3, s[24:27], s45 offen sc1
    buffer_store_dwordx4 v[152:155], v3, s[24:27], s46 offen sc1
    buffer_store_dwordx4 v[144:147], v3, s[24:27], s67 offen sc1
    s_lshl_b32 s45, s63, 2
    s_add_u32 s45, s45, s29
    s_lshl_b32 s46, s20, 2
    s_add_u32 s46, s46, s71
    v_mov_b32 v6, s45
    v_writelane_b32 v6, s46, 0
    v_lshlrev_b32 v5, 2, v1
    v_add_u32 v13, s71, v5
    s_sub_u32 s45, s29, 64
    v_add_u32 v5, s45, v5
    v_cmp_lt_u32 vcc, 15, v1
    s_nop 1
    v_cndmask_b32 v13, v13, v5, vcc
    v_mov_b32 v14, 1
    v_mov_b32 v2, 110352
    v_mov_b32 v4, 1
    s_waitcnt vmcnt(0)
    s_mov_b64 exec, 1
    ds_add_rtn_u32 v5, v2, v4
    s_mov_b64 exec, -1
    v_mov_b32 v2, 110356
    s_waitcnt lgkmcnt(0)
    v_readfirstlane_b32 s46, v5
    s_cmp_lg_u32 s46, 1
    s_cbranch_scc1 K2_wgo
    s_mov_b64 exec, 3
    buffer_store_dword v4, v6, s[24:27], 0 offen sc1
    s_mov_b64 exec, s[58:59]
    s_mov_b32 s67, 300
K2_poll:
    buffer_load_dword v5, v13, s[24:27], 0 offen sc1
    s_waitcnt vmcnt(0)
    v_cmp_ne_u32 vcc, v5, v14
    s_cbranch_vccz K2_pgo
    s_sleep 4
    s_sub_u32 s67, s67, 1
    s_cmp_lg_u32 s67, 0
    s_cbranch_scc1 K2_poll
    v_mov_b32 v4, 2
K2_pgo:
    ds_write_b32 v2, v4
    s_mov_b64 exec, -1
K2_wgo:
    ds_read_b32 v5, v2
    s_waitcnt lgkmcnt(0)
    v_readfirstlane_b32 s46, v5
    s_cmp_lg_u32 s46, 0
    s_cbranch_scc1 K2_wgot
    s_sleep 3
    s_branch K2_wgo
K2_wgot:
    s_cmp_eq_u32 s46, 1
    s_cbranch_scc1 K2_bb
    s_mov_b32 s70, 1
    s_mov_b32 s68, 0
    s_branch K2_bs
K2_bb:
    s_mov_b64 exec, -1
    s_lshl_b32 s32, s60, 1
    s_add_u32 s32, s32, s61
    s_lshl_b32 s32, s32, 4
    s_add_u32 s32, s32, s63
    s_mul_i32 s32, s32, 20672
    s_add_u32 s32, s32, 6356992
    s_lshl_b32 s54, s61, 8
    s_add_u32 s54, s54, s57
    s_lshl_b32 s33, s60, 4
    s_add_u32 s33, s33, s54
    buffer_load_dwordx4 v[72:75], v3, s[24:27], s30 offen offset:0 sc1
    buffer_load_dwordx4 v[76:79], v9, s[24:27], s32 offen offset:0 sc1
    buffer_load_dwordx4 v[80:83], v3, s[24:27], s30 offen offset:1024 sc1
    buffer_load_dwordx4 v[84:87], v9, s[24:27], s32 offen offset:608 sc1
    buffer_load_dwordx4 v[88:91], v3, s[24:27], s30 offen offset:2048 sc1
    buffer_load_dwordx4 v[92:95], v9, s[24:27], s32 offen offset:1216 sc1
    buffer_load_dwordx4 v[96:99], v3, s[24:27], s30 offen offset:3072 sc1
    buffer_load_dwordx4 v[100:103], v9, s[24:27], s32 offen offset:1824 sc1
    s_add_u32 s30, s30, 4096
    buffer_load_dwordx4 v[104:107], v3, s[24:27], s30 offen offset:0 sc1
    buffer_load_dwordx4 v[108:111], v9, s[24:27], s32 offen offset:2432 sc1
    buffer_load_dwordx4 v[112:115], v3, s[24:27], s30 offen offset:1024 sc1
    buffer_load_dwordx4 v[116:119], v9, s[24:27], s32 offen offset:3040 sc1
    s_add_u32 s32, s32, 3648
    buffer_load_dwordx4 v[120:123], v3, s[24:27], s30 offen offset:2048 sc1
    buffer_load_dwordx4 v[124:127], v9, s[24:27], s32 offen offset:0 sc1
    buffer_load_dwordx4 v[128:131], v3, s[24:27], s30 offen offset:3072 sc1
    buffer_load_dwordx4 v[132:135], v9, s[24:27], s32 offen offset:608 sc1
    s_add_u32 s30, s30, 4096
    buffer_load_dwordx4 v[136:139], v3, s[24:27], s30 offen offset:0 sc1
    buffer_load_dwordx4 v[140:143], v9, s[24:27], s32 offen offset:1216 sc1
    buffer_load_dwordx4 v[144:147], v3, s[24:27], s30 offen offset:1024 sc1
    buffer_load_dwordx4 v[148:151], v9, s[24:27], s32 offen offset:1824 sc1
    buffer_load_dwordx4 v[152:155], v3, s[24:27], s30 offen offset:2048 sc1
    buffer_load_dwordx4 v[156:159], v9, s[24:27], s32 offen offset:2432 sc1
    buffer_load_dwordx4 v[160:163], v3, s[24:27], s30 offen offset:3072 sc1
    buffer_load_dwordx4 v[164:167], v9, s[24:27], s32 offen offset:3040 sc1
    v_mov_b32 v68, 0xbf803f80
    v_mov_b32 v69, 0xbf803f80
    v_mov_b32 v70, 0xbf803f80
    v_mov_b32 v71, 0xbf803f80
    v_mov_b32 v48, 0
    v_mov_b32 v49, 0
    v_mov_b32 v50, 0
    v_mov_b32 v51, 0
    v_mov_b32 v52, 0
    v_mov_b32 v53, 0
    v_mov_b32 v54, 0
    v_mov_b32 v55, 0
    v_mov_b32 v56, 0
    v_mov_b32 v57, 0
    v_mov_b32 v58, 0
    v_mov_b32 v59, 0
    v_mov_b32 v60, 0
    v_mov_b32 v61, 0
    v_mov_b32 v62, 0
    v_mov_b32 v63, 0
    s_mul_i32 s67, s63, 18
    v_add_u32 v2, s67, v10
    v_lshlrev_b32 v12, 1, v2
    v_sub_u32 v13, 2304, v12
    v_add_u32 v12, 1152, v12
    v_mov_b32 v6, 0x40000000
    s_cmp_eq_u32 s63, 15
    s_cselect_b32 s67, 18, 17
    v_cmp_lt_u32 vcc, s67, v10
    s_nop 1
    v_cndmask_b32 v12, v12, v6, vcc
    v_cmp_lt_u32 vcc, 17, v10
    s_nop 1
    v_cndmask_b32 v13, v13, v6, vcc
    v_cmp_eq_u32 vcc, 0, v2
    s_nop 1
    v_cndmask_b32 v13, v13, v6, vcc
    s_lshl_b32 s67, s57, 6
    s_add_u32 s67, s67, s61
    s_lshl_b32 s45, s60, 10
    s_add_u32 s67, s67, s45
    v_lshlrev_b32 v2, 3, v11
    v_add_u32 v2, s67, v2
    v_mul_u32_u24 v2, 2304, v2
    v_sub_u32 v4, 4594176, v2
    v_add_u32 v14, v2, v12
    v_add_u32 v15, v2, v13
    v_add_u32 v64, v4, v12
    v_add_u32 v65, v4, v13
    s_lshl_b32 s45, s60, 13
    s_add_u32 s45, s45, 129024
    v_add_u32 v66, s45, v3
    s_xor_b32 s45, s60, 1
    s_lshl_b32 s45, s45, 13
    s_add_u32 s45, s45, 129024
    v_add_u32 v67, s45, v3
    s_waitcnt vmcnt(22)
    v_mfma_f32_32x32x16_bf16 v[16:31], v[72:75], v[76:79], 0
    s_cmp_lg_u32 s33, 7
    s_cbranch_scc1 K2_bx0
    v_mfma_f32_32x32x16_bf16 v[48:63], v[68:71], v[76:79], v[48:63]
K2_bx0:
    s_add_u32 s30, s30, 4096
    s_add_u32 s32, s32, 3648
    buffer_load_dwordx4 v[72:75], v3, s[24:27], s30 offen offset:0 sc1
    buffer_load_dwordx4 v[76:79], v9, s[24:27], s32 offen offset:0 sc1
    s_waitcnt vmcnt(22)
    v_mfma_f32_32x32x16_bf16 v[16:31], v[80:83], v[84:87], v[16:31]
    s_cmp_lg_u32 s33, 7
    s_cbranch_scc1 K2_bx1
    v_mfma_f32_32x32x16_bf16 v[48:63], v[68:71], v[84:87], v[48:63]
K2_bx1:
    buffer_load_dwordx4 v[80:83], v3, s[24:27], s30 offen offset:1024 sc1
    buffer_load_dwordx4 v[84:87], v9, s[24:27], s32 offen offset:608 sc1
    s_waitcnt vmcnt(22)
    v_mfma_f32_32x32x16_bf16 v[16:31], v[88:91], v[92:95], v[16:31]
    s_cmp_lg_u32 s33, 7
    s_cbranch_scc1 K2_bx2
    v_mfma_f32_32x32x16_bf16 v[48:63], v[68:71], v[92:95], v[48:63]
K2_bx2:
    buffer_load_dwordx4 v[88:91], v3, s[24:27], s30 offen offset:2048 sc1
    buffer_load_dwordx4 v[92:95], v9, s[24:27], s32 offen offset:1216 sc1
    s_waitcnt vmcnt(22)
    v_mfma_f32_32x32x16_bf16 v[16:31], v[96:99], v[100:103], v[16:31]
    s_cmp_lg_u32 s33, 7
    s_cbranch_scc1 K2_bx3
    v_mfma_f32_32x32x16_bf16 v[48:63], v[68:71], v[100:103], v[48:63]
K2_bx3:
    buffer_load_dwordx4 v[96:99], v3, s[24:27], s30 offen offset:3072 sc1
    buffer_load_dwordx4 v[100:103], v9, s[24:27], s32 offen offset:1824 sc1
    s_waitcnt vmcnt(22)
    v_mfma_f32_32x32x16_bf16 v[16:31], v[104:107], v[108:111], v[16:31]
    s_cmp_lg_u32 s33, 7
    s_cbranch_scc1 K2_bx4
    v_mfma_f32_32x32x16_bf16 v[48:63], v[68:71], v[108:111], v[48:63]
K2_bx4:
    s_add_u32 s30, s30, 4096
    buffer_load_dwordx4 v[104:107], v3, s[24:27], s30 offen offset:0 sc1
    buffer_load_dwordx4 v[108:111], v9, s[24:27], s32 offen offset:2432 sc1
    s_waitcnt vmcnt(22)
    v_mfma_f32_32x32x16_bf16 v[16:31], v[112:115], v[116:119], v[16:31]
    s_cmp_lg_u32 s33, 7
    s_cbranch_scc1 K2_bx5
    v_mfma_f32_32x32x16_bf16 v[48:63], v[68:71], v[116:119], v[48:63]
K2_bx5:
    buffer_load_dwordx4 v[112:115], v3, s[24:27], s30 offen offset:1024 sc1
    buffer_load_dwordx4 v[116:119], v9, s[24:27], s32 offen offset:3040 sc1
    s_waitcnt vmcnt(22)
    v_mfma_f32_32x32x16_bf16 v[16:31], v[120:123], v[124:127], v[16:31]
    s_cmp_lg_u32 s33, 7
    s_cbranch_scc1 K2_bx6
    v_mfma_f32_32x32x16_bf16 v[48:63], v[68:71], v[124:127], v[48:63]
K2_bx6:
    s_add_u32 s32, s32, 3648
    buffer_load_dwordx4 v[120:123], v3, s[24:27], s30 offen offset:2048 sc1
    buffer_load_dwordx4 v[124:127], v9, s[24:27], s32 offen offset:0 sc1
    s_waitcnt vmcnt(22)
    v_mfma_f32_32x32x16_bf16 v[16:31], v[128:131], v[132:135], v[16:31]
    s_cmp_lg_u32 s33, 7
    s_cbranch_scc1 K2_bx7
    v_mfma_f32_32x32x16_bf16 v[48:63], v[68:71], v[132:135], v[48:63]
K2_bx7:
    buffer_load_dwordx4 v[128:131], v3, s[24:27], s30 offen offset:3072 sc1
    buffer_load_dwordx4 v[132:135], v9, s[24:27], s32 offen offset:608 sc1
    s_waitcnt vmcnt(22)
    v_mfma_f32_32x32x16_bf16 v[16:31], v[136:139], v[140:143], v[16:31]
    s_cmp_lg_u32 s33, 7
    s_cbranch_scc1 K2_bx8
    v_mfma_f32_32x32x16_bf16 v[48:63], v[68:71], v[140:143], v[48:63]
K2_bx8:
    s_add_u32 s30, s30, 4096
    buffer_load_dwordx4 v[136:139], v3, s[24:27], s30 offen offset:0 sc1
    buffer_load_dwordx4 v[140:143], v9, s[24:27], s32 offen offset:1216 sc1
    s_waitcnt vmcnt(22)
    v_mfma_f32_32x32x16_bf16 v[16:31], v[144:147], v[148:151], v[16:31]
    s_cmp_lg_u32 s33, 7
    s_cbranch_scc1 K2_bx9
    v_mfma_f32_32x32x16_bf16 v[48:63], v[68:71], v[148:151], v[48:63]
K2_bx9:
    buffer_load_dwordx4 v[144:147], v3, s[24:27], s30 offen offset:1024 sc1
    buffer_load_dwordx4 v[148:151], v9, s[24:27], s32 offen offset:1824 sc1
    s_waitcnt vmcnt(22)
    v_mfma_f32_32x32x16_bf16 v[16:31], v[152:155], v[156:159], v[16:31]
    s_cmp_lg_u32 s33, 7
    s_cbranch_scc1 K2_bx10
    v_mfma_f32_32x32x16_bf16 v[48:63], v[68:71], v[156:159], v[48:63]
K2_bx10:
    buffer_load_dwordx4 v[152:155], v3, s[24:27], s30 offen offset:2048 sc1
    buffer_load_dwordx4 v[156:159], v9, s[24:27], s32 offen offset:2432 sc1
    s_waitcnt vmcnt(22)
    v_mfma_f32_32x32x16_bf16 v[16:31], v[160:163], v[164:167], v[16:31]
    s_cmp_lg_u32 s33, 7
    s_cbranch_scc1 K2_bx11
    v_mfma_f32_32x32x16_bf16 v[48:63], v[68:71], v[164:167], v[48:63]
K2_bx11:
    buffer_load_dwordx4 v[160:163], v3, s[24:27], s30 offen offset:3072 sc1
    buffer_load_dwordx4 v[164:167], v9, s[24:27], s32 offen offset:3040 sc1
    s_waitcnt vmcnt(22)
    v_mfma_f32_32x32x16_bf16 v[16:31], v[72:75], v[76:79], v[16:31]
    s_cmp_lg_u32 s33, 7
    s_cbranch_scc1 K2_bx12
    v_mfma_f32_32x32x16_bf16 v[48:63], v[68:71], v[76:79], v[48:63]
K2_bx12:
    s_add_u32 s30, s30, 4096
    s_add_u32 s32, s32, 3648
    buffer_load_dwordx4 v[72:75], v3, s[24:27], s30 offen offset:0 sc1
    buffer_load_dwordx4 v[76:79], v9, s[24:27], s32 offen offset:0 sc1
    s_waitcnt vmcnt(22)
    v_mfma_f32_32x32x16_bf16 v[16:31], v[80:83], v[84:87], v[16:31]
    s_cmp_lg_u32 s33, 7
    s_cbranch_scc1 K2_bx13
    v_mfma_f32_32x32x16_bf16 v[48:63], v[68:71], v[84:87], v[48:63]
K2_bx13:
    buffer_load_dwordx4 v[80:83], v3, s[24:27], s30 offen offset:1024 sc1
    buffer_load_dwordx4 v[84:87], v9, s[24:27], s32 offen offset:608 sc1
    s_waitcnt vmcnt(22)
    v_mfma_f32_32x32x16_bf16 v[16:31], v[88:91], v[92:95], v[16:31]
    s_cmp_lg_u32 s33, 7
    s_cbranch_scc1 K2_bx14
    v_mfma_f32_32x32x16_bf16 v[48:63], v[68:71], v[92:95], v[48:63]
K2_bx14:
    buffer_load_dwordx4 v[88:91], v3, s[24:27], s30 offen offset:2048 sc1
    buffer_load_dwordx4 v[92:95], v9, s[24:27], s32 offen offset:1216 sc1
    s_waitcnt vmcnt(22)
    v_mfma_f32_32x32x16_bf16 v[16:31], v[96:99], v[100:103], v[16:31]
    s_cmp_lg_u32 s33, 7
    s_cbranch_scc1 K2_bx15
    v_mfma_f32_32x32x16_bf16 v[48:63], v[68:71], v[100:103], v[48:63]
K2_bx15:
    buffer_load_dwordx4 v[96:99], v3, s[24:27], s30 offen offset:3072 sc1
    buffer_load_dwordx4 v[100:103], v9, s[24:27], s32 offen offset:1824 sc1
    s_waitcnt vmcnt(22)
    v_mfma_f32_32x32x16_bf16 v[32:47], v[104:107], v[108:111], 0
    s_cmp_lg_u32 s33, 23
    s_cbranch_scc1 K2_bx16
    v_mfma_f32_32x32x16_bf16 v[48:63], v[68:71], v[108:111], v[48:63]
K2_bx16:
    s_add_u32 s30, s30, 4096
    buffer_load_dwordx4 v[104:107], v3, s[24:27], s30 offen offset:0 sc1
    buffer_load_dwordx4 v[108:111], v9, s[24:27], s32 offen offset:2432 sc1
    s_waitcnt vmcnt(22)
    v_mfma_f32_32x32x16_bf16 v[32:47], v[112:115], v[116:119], v[32:47]
    s_cmp_lg_u32 s33, 23
    s_cbranch_scc1 K2_bx17
    v_mfma_f32_32x32x16_bf16 v[48:63], v[68:71], v[116:119], v[48:63]
K2_bx17:
    buffer_load_dwordx4 v[112:115], v3, s[24:27], s30 offen offset:1024 sc1
    buffer_load_dwordx4 v[116:119], v9, s[24:27], s32 offen offset:3040 sc1
    s_waitcnt vmcnt(22)
    v_mfma_f32_32x32x16_bf16 v[32:47], v[120:123], v[124:127], v[32:47]
    s_cmp_lg_u32 s33, 23
    s_cbranch_scc1 K2_bx18
    v_mfma_f32_32x32x16_bf16 v[48:63], v[68:71], v[124:127], v[48:63]
K2_bx18:
    s_add_u32 s32, s32, 3648
    buffer_load_dwordx4 v[120:123], v3, s[24:27], s30 offen offset:2048 sc1
    buffer_load_dwordx4 v[124:127], v9, s[24:27], s32 offen offset:0 sc1
    s_waitcnt vmcnt(22)
    v_mfma_f32_32x32x16_bf16 v[32:47], v[128:131], v[132:135], v[32:47]
    s_cmp_lg_u32 s33, 23
    s_cbranch_scc1 K2_bx19
    v_mfma_f32_32x32x16_bf16 v[48:63], v[68:71], v[132:135], v[48:63]
K2_bx19:
    buffer_load_dwordx4 v[128:131], v3, s[24:27], s30 offen offset:3072 sc1
    buffer_load_dwordx4 v[132:135], v9, s[24:27], s32 offen offset:608 sc1
    s_waitcnt vmcnt(22)
    v_mfma_f32_32x32x16_bf16 v[32:47], v[136:139], v[140:143], v[32:47]
    s_cmp_lg_u32 s33, 23
    s_cbranch_scc1 K2_bx20
    v_mfma_f32_32x32x16_bf16 v[48:63], v[68:71], v[140:143], v[48:63]
K2_bx20:
    s_add_u32 s30, s30, 4096
    buffer_load_dwordx4 v[136:139], v3, s[24:27], s30 offen offset:0 sc1
    buffer_load_dwordx4 v[140:143], v9, s[24:27], s32 offen offset:1216 sc1
    s_waitcnt vmcnt(22)
    v_mfma_f32_32x32x16_bf16 v[32:47], v[144:147], v[148:151], v[32:47]
    s_cmp_lg_u32 s33, 23
    s_cbranch_scc1 K2_bx21
    v_mfma_f32_32x32x16_bf16 v[48:63], v[68:71], v[148:151], v[48:63]
K2_bx21:
    s_waitcnt vmcnt(20)
    v_mfma_f32_32x32x16_bf16 v[32:47], v[152:155], v[156:159], v[32:47]
    s_cmp_lg_u32 s33, 23
    s_cbranch_scc1 K2_bx22
    v_mfma_f32_32x32x16_bf16 v[48:63], v[68:71], v[156:159], v[48:63]
K2_bx22:
    s_waitcnt vmcnt(18)
    v_mfma_f32_32x32x16_bf16 v[32:47], v[160:163], v[164:167], v[32:47]
    s_cmp_lg_u32 s33, 23
    s_cbranch_scc1 K2_bx23
    v_mfma_f32_32x32x16_bf16 v[48:63], v[68:71], v[164:167], v[48:63]
K2_bx23:
    s_waitcnt vmcnt(16)
    v_mfma_f32_32x32x16_bf16 v[32:47], v[72:75], v[76:79], v[32:47]
    s_cmp_lg_u32 s33, 23
    s_cbranch_scc1 K2_bx24
    v_mfma_f32_32x32x16_bf16 v[48:63], v[68:71], v[76:79], v[48:63]
K2_bx24:
    s_waitcnt vmcnt(14)
    v_mfma_f32_32x32x16_bf16 v[32:47], v[80:83], v[84:87], v[32:47]
    s_cmp_lg_u32 s33, 23
    s_cbranch_scc1 K2_bx25
    v_mfma_f32_32x32x16_bf16 v[48:63], v[68:71], v[84:87], v[48:63]
K2_bx25:
    s_waitcnt vmcnt(12)
    v_mfma_f32_32x32x16_bf16 v[32:47], v[88:91], v[92:95], v[32:47]
    s_cmp_lg_u32 s33, 23
    s_cbranch_scc1 K2_bx26
    v_mfma_f32_32x32x16_bf16 v[48:63], v[68:71], v[92:95], v[48:63]
K2_bx26:
    s_waitcnt vmcnt(10)
    v_mfma_f32_32x32x16_bf16 v[32:47], v[96:99], v[100:103], v[32:47]
    s_cmp_lg_u32 s33, 23
    s_cbranch_scc1 K2_bx27
    v_mfma_f32_32x32x16_bf16 v[48:63], v[68:71], v[100:103], v[48:63]
K2_bx27:
    s_waitcnt vmcnt(8)
    v_mfma_f32_32x32x16_bf16 v[32:47], v[104:107], v[108:111], v[32:47]
    s_cmp_lg_u32 s33, 23
    s_cbranch_scc1 K2_bx28
    v_mfma_f32_32x32x16_bf16 v[48:63], v[68:71], v[108:111], v[48:63]
K2_bx28:
    s_waitcnt vmcnt(6)
    v_mfma_f32_32x32x16_bf16 v[32:47], v[112:115], v[116:119], v[32:47]
    s_cmp_lg_u32 s33, 23
    s_cbranch_scc1 K2_bx29
    v_mfma_f32_32x32x16_bf16 v[48:63], v[68:71], v[116:119], v[48:63]
K2_bx29:
    s_waitcnt vmcnt(4)
    v_mfma_f32_32x32x16_bf16 v[32:47], v[120:123], v[124:127], v[32:47]
    s_cmp_lg_u32 s33, 23
    s_cbranch_scc1 K2_bx30
    v_mfma_f32_32x32x16_bf16 v[48:63], v[68:71], v[124:127], v[48:63]
K2_bx30:
    s_waitcnt vmcnt(2)
    v_mfma_f32_32x32x16_bf16 v[32:47], v[128:131], v[132:135], v[32:47]
    s_cmp_lg_u32 s33, 23
    s_cbranch_scc1 K2_bx31
    v_mfma_f32_32x32x16_bf16 v[48:63], v[68:71], v[132:135], v[48:63]
K2_bx31:
    s_waitcnt vmcnt(0)
    v_mfma_f32_32x32x16_bf16 v[16:31], v[136:139], v[140:143], v[16:31]
    s_cmp_lg_u32 s33, 7
    s_cbranch_scc1 K2_bx32
    v_mfma_f32_32x32x16_bf16 v[48:63], v[68:71], v[140:143], v[48:63]
K2_bx32:
    s_cmp_eq_u32 s60, 0
    s_cselect_b32 s45, 1.0, -1.0
    s_nop 7
    v_fma_f32 v72, v32, s45, v16
    v_fma_f32 v88, -v32, s45, v16
    v_fma_f32 v73, v33, s45, v17
    v_fma_f32 v89, -v33, s45, v17
    v_fma_f32 v74, v34, s45, v18
    v_fma_f32 v90, -v34, s45, v18
    v_fma_f32 v75, v35, s45, v19
    v_fma_f32 v91, -v35, s45, v19
    v_fma_f32 v76, v36, s45, v20
    v_fma_f32 v92, -v36, s45, v20
    v_fma_f32 v77, v37, s45, v21
    v_fma_f32 v93, -v37, s45, v21
    v_fma_f32 v78, v38, s45, v22
    v_fma_f32 v94, -v38, s45, v22
    v_fma_f32 v79, v39, s45, v23
    v_fma_f32 v95, -v39, s45, v23
    v_fma_f32 v80, v40, s45, v24
    v_fma_f32 v96, -v40, s45, v24
    v_fma_f32 v81, v41, s45, v25
    v_fma_f32 v97, -v41, s45, v25
    v_fma_f32 v82, v42, s45, v26
    v_fma_f32 v98, -v42, s45, v26
    v_fma_f32 v83, v43, s45, v27
    v_fma_f32 v99, -v43, s45, v27
    v_fma_f32 v84, v44, s45, v28
    v_fma_f32 v100, -v44, s45, v28
    v_fma_f32 v85, v45, s45, v29
    v_fma_f32 v101, -v45, s45, v29
    v_fma_f32 v86, v46, s45, v30
    v_fma_f32 v102, -v46, s45, v30
    v_fma_f32 v87, v47, s45, v31
    v_fma_f32 v103, -v47, s45, v31
    ds_write_b128 v66, v[88:91] offset:0
    ds_write_b128 v66, v[92:95] offset:1024
    ds_write_b128 v66, v[96:99] offset:2048
    ds_write_b128 v66, v[100:103] offset:3072
    ds_write_b32 v66, v48 offset:4096
    s_lshl_b32 s46, s60, 2
    s_add_u32 s46, s46, 110376
    v_mov_b32 v2, s46
    v_mov_b32 v4, 1
    ds_write_b32 v2, v4
    s_xor_b32 s46, s46, 4
    v_mov_b32 v2, s46
K2_xw:
    ds_read_b32 v4, v2
    s_waitcnt lgkmcnt(0)
    v_readfirstlane_b32 s46, v4
    s_cmp_lg_u32 s46, 0
    s_cbranch_scc1 K2_xo
    s_sleep 1
    s_branch K2_xw
K2_xo:
    ds_read_b128 v[104:107], v67 offset:0
    ds_read_b128 v[108:111], v67 offset:1024
    ds_read_b128 v[112:115], v67 offset:2048
    ds_read_b128 v[116:119], v67 offset:3072
    ds_read_b32 v49, v67 offset:4096
    s_waitcnt lgkmcnt(0)
    v_sub_f32 v88, v72, v104
    v_add_f32 v72, v72, v104
    v_mul_f32 v88, s45, v88
    s_mov_b32 s67, 0
    v_cvt_pk_bf16_f32 v72, v88, v72
    s_mov_b32 s46, 124416
    buffer_store_short v72, v14, s[36:39], s67 offen nt
    buffer_store_short_d16_hi v72, v15, s[36:39], s67 offen nt
    buffer_store_short_d16_hi v72, v64, s[36:39], s46 offen nt
    buffer_store_short v72, v65, s[36:39], s46 offen nt
    v_sub_f32 v89, v73, v105
    v_add_f32 v73, v73, v105
    v_mul_f32 v89, s45, v89
    s_mov_b32 s67, 4608
    v_cvt_pk_bf16_f32 v73, v89, v73
    s_mov_b32 s46, 119808
    buffer_store_short v73, v14, s[36:39], s67 offen nt
    buffer_store_short_d16_hi v73, v15, s[36:39], s67 offen nt
    buffer_store_short_d16_hi v73, v64, s[36:39], s46 offen nt
    buffer_store_short v73, v65, s[36:39], s46 offen nt
    v_sub_f32 v90, v74, v106
    v_add_f32 v74, v74, v106
    v_mul_f32 v90, s45, v90
    s_mov_b32 s67, 9216
    v_cvt_pk_bf16_f32 v74, v90, v74
    s_mov_b32 s46, 115200
    buffer_store_short v74, v14, s[36:39], s67 offen nt
    buffer_store_short_d16_hi v74, v15, s[36:39], s67 offen nt
    buffer_store_short_d16_hi v74, v64, s[36:39], s46 offen nt
    buffer_store_short v74, v65, s[36:39], s46 offen nt
    v_sub_f32 v91, v75, v107
    v_add_f32 v75, v75, v107
    v_mul_f32 v91, s45, v91
    s_mov_b32 s67, 13824
    v_cvt_pk_bf16_f32 v75, v91, v75
    s_mov_b32 s46, 110592
    buffer_store_short v75, v14, s[36:39], s67 offen nt
    buffer_store_short_d16_hi v75, v15, s[36:39], s67 offen nt
    buffer_store_short_d16_hi v75, v64, s[36:39], s46 offen nt
    buffer_store_short v75, v65, s[36:39], s46 offen nt
    v_sub_f32 v92, v76, v108
    v_add_f32 v76, v76, v108
    v_mul_f32 v92, s45, v92
    s_mov_b32 s67, 36864
    v_cvt_pk_bf16_f32 v76, v92, v76
    s_mov_b32 s46, 87552
    buffer_store_short v76, v14, s[36:39], s67 offen nt
    buffer_store_short_d16_hi v76, v15, s[36:39], s67 offen nt
    buffer_store_short_d16_hi v76, v64, s[36:39], s46 offen nt
    buffer_store_short v76, v65, s[36:39], s46 offen nt
    v_sub_f32 v93, v77, v109
    v_add_f32 v77, v77, v109
    v_mul_f32 v93, s45, v93
    s_mov_b32 s67, 41472
    v_cvt_pk_bf16_f32 v77, v93, v77
    s_mov_b32 s46, 82944
    buffer_store_short v77, v14, s[36:39], s67 offen nt
    buffer_store_short_d16_hi v77, v15, s[36:39], s67 offen nt
    buffer_store_short_d16_hi v77, v64, s[36:39], s46 offen nt
    buffer_store_short v77, v65, s[36:39], s46 offen nt
    v_sub_f32 v94, v78, v110
    v_add_f32 v78, v78, v110
    v_mul_f32 v94, s45, v94
    s_mov_b32 s67, 46080
    v_cvt_pk_bf16_f32 v78, v94, v78
    s_mov_b32 s46, 78336
    buffer_store_short v78, v14, s[36:39], s67 offen nt
    buffer_store_short_d16_hi v78, v15, s[36:39], s67 offen nt
    buffer_store_short_d16_hi v78, v64, s[36:39], s46 offen nt
    buffer_store_short v78, v65, s[36:39], s46 offen nt
    v_sub_f32 v95, v79, v111
    v_add_f32 v79, v79, v111
    v_mul_f32 v95, s45, v95
    s_mov_b32 s67, 50688
    v_cvt_pk_bf16_f32 v79, v95, v79
    s_mov_b32 s46, 73728
    buffer_store_short v79, v14, s[36:39], s67 offen nt
    buffer_store_short_d16_hi v79, v15, s[36:39], s67 offen nt
    buffer_store_short_d16_hi v79, v64, s[36:39], s46 offen nt
    buffer_store_short v79, v65, s[36:39], s46 offen nt
    v_sub_f32 v96, v80, v112
    v_add_f32 v80, v80, v112
    v_mul_f32 v96, s45, v96
    s_mov_b32 s67, 73728
    v_cvt_pk_bf16_f32 v80, v96, v80
    s_mov_b32 s46, 50688
    buffer_store_short v80, v14, s[36:39], s67 offen nt
    buffer_store_short_d16_hi v80, v15, s[36:39], s67 offen nt
    buffer_store_short_d16_hi v80, v64, s[36:39], s46 offen nt
    buffer_store_short v80, v65, s[36:39], s46 offen nt
    v_sub_f32 v97, v81, v113
    v_add_f32 v81, v81, v113
    v_mul_f32 v97, s45, v97
    s_mov_b32 s67, 78336
    v_cvt_pk_bf16_f32 v81, v97, v81
    s_mov_b32 s46, 46080
    buffer_store_short v81, v14, s[36:39], s67 offen nt
    buffer_store_short_d16_hi v81, v15, s[36:39], s67 offen nt
    buffer_store_short_d16_hi v81, v64, s[36:39], s46 offen nt
    buffer_store_short v81, v65, s[36:39], s46 offen nt
    v_sub_f32 v98, v82, v114
    v_add_f32 v82, v82, v114
    v_mul_f32 v98, s45, v98
    s_mov_b32 s67, 82944
    v_cvt_pk_bf16_f32 v82, v98, v82
    s_mov_b32 s46, 41472
    buffer_store_short v82, v14, s[36:39], s67 offen nt
    buffer_store_short_d16_hi v82, v15, s[36:39], s67 offen nt
    buffer_store_short_d16_hi v82, v64, s[36:39], s46 offen nt
    buffer_store_short v82, v65, s[36:39], s46 offen nt
    v_sub_f32 v99, v83, v115
    v_add_f32 v83, v83, v115
    v_mul_f32 v99, s45, v99
    s_mov_b32 s67, 87552
    v_cvt_pk_bf16_f32 v83, v99, v83
    s_mov_b32 s46, 36864
    buffer_store_short v83, v14, s[36:39], s67 offen nt
    buffer_store_short_d16_hi v83, v15, s[36:39], s67 offen nt
    buffer_store_short_d16_hi v83, v64, s[36:39], s46 offen nt
    buffer_store_short v83, v65, s[36:39], s46 offen nt
    v_sub_f32 v100, v84, v116
    v_add_f32 v84, v84, v116
    v_mul_f32 v100, s45, v100
    s_mov_b32 s67, 110592
    v_cvt_pk_bf16_f32 v84, v100, v84
    s_mov_b32 s46, 13824
    buffer_store_short v84, v14, s[36:39], s67 offen nt
    buffer_store_short_d16_hi v84, v15, s[36:39], s67 offen nt
    buffer_store_short_d16_hi v84, v64, s[36:39], s46 offen nt
    buffer_store_short v84, v65, s[36:39], s46 offen nt
    v_sub_f32 v101, v85, v117
    v_add_f32 v85, v85, v117
    v_mul_f32 v101, s45, v101
    s_mov_b32 s67, 115200
    v_cvt_pk_bf16_f32 v85, v101, v85
    s_mov_b32 s46, 9216
    buffer_store_short v85, v14, s[36:39], s67 offen nt
    buffer_store_short_d16_hi v85, v15, s[36:39], s67 offen nt
    buffer_store_short_d16_hi v85, v64, s[36:39], s46 offen nt
    buffer_store_short v85, v65, s[36:39], s46 offen nt
    v_sub_f32 v102, v86, v118
    v_add_f32 v86, v86, v118
    v_mul_f32 v102, s45, v102
    s_mov_b32 s67, 119808
    v_cvt_pk_bf16_f32 v86, v102, v86
    s_mov_b32 s46, 4608
    buffer_store_short v86, v14, s[36:39], s67 offen nt
    buffer_store_short_d16_hi v86, v15, s[36:39], s67 offen nt
    buffer_store_short_d16_hi v86, v64, s[36:39], s46 offen nt
    buffer_store_short v86, v65, s[36:39], s46 offen nt
    v_sub_f32 v103, v87, v119
    v_add_f32 v87, v87, v119
    v_mul_f32 v103, s45, v103
    s_mov_b32 s67, 124416
    v_cvt_pk_bf16_f32 v87, v103, v87
    s_mov_b32 s46, 0
    buffer_store_short v87, v14, s[36:39], s67 offen nt
    buffer_store_short_d16_hi v87, v15, s[36:39], s67 offen nt
    buffer_store_short_d16_hi v87, v64, s[36:39], s46 offen nt
    buffer_store_short v87, v65, s[36:39], s46 offen nt
    s_cmp_lg_u32 s33, 7
    s_cbranch_scc1 K2_bdone
    v_add_f32 v50, v48, v49
    v_sub_f32 v51, v48, v49
    v_cvt_pk_bf16_f32 v48, v50, v51
    s_mov_b32 s67, 1179648
    s_mov_b32 s46, 3538944
    s_mov_b32 exec_hi, 0
    buffer_store_short v48, v12, s[36:39], s67 offen nt
    buffer_store_short_d16_hi v48, v13, s[36:39], s67 offen nt
    buffer_store_short_d16_hi v48, v12, s[36:39], s46 offen nt
    buffer_store_short v48, v13, s[36:39], s46 offen nt
    s_mov_b32 exec_hi, -1
K2_bdone:
    s_lshl_b32 s32, s60, 1
    s_waitcnt vmcnt(0)
    s_mul_i32 s33, s32, 9216
    s_add_u32 s33, s33, 8028160
    s_add_u32 s33, s33, 36864
    s_add_u32 s34, s33, 4096
    s_add_u32 s35, s33, 8192
    buffer_load_dwordx4 v[96:99], v3, s[24:27], s33 offen offset:0
    buffer_load_dwordx4 v[100:103], v3, s[24:27], s33 offen offset:1024
    buffer_load_dwordx4 v[104:107], v3, s[24:27], s33 offen offset:2048
    buffer_load_dwordx4 v[108:111], v3, s[24:27], s33 offen offset:3072
    buffer_load_dwordx4 v[112:115], v3, s[24:27], s34 offen offset:0
    buffer_load_dwordx4 v[116:119], v3, s[24:27], s34 offen offset:1024
    buffer_load_dwordx4 v[120:123], v3, s[24:27], s34 offen offset:2048
    buffer_load_dwordx4 v[124:127], v3, s[24:27], s34 offen offset:3072
    buffer_load_dwordx4 v[128:131], v3, s[24:27], s35 offen offset:0
    s_add_u32 s33, s33, 36864
    s_add_u32 s34, s33, 4096
    s_add_u32 s35, s33, 8192
    buffer_load_dwordx4 v[8:11], v3, s[24:27], s33 offen offset:0
    buffer_load_dwordx4 v[12:15], v3, s[24:27], s33 offen offset:1024
    buffer_load_dwordx4 v[16:19], v3, s[24:27], s33 offen offset:2048
    buffer_load_dwordx4 v[20:23], v3, s[24:27], s33 offen offset:3072
    buffer_load_dwordx4 v[24:27], v3, s[24:27], s34 offen offset:0
    buffer_load_dwordx4 v[28:31], v3, s[24:27], s34 offen offset:1024
    buffer_load_dwordx4 v[32:35], v3, s[24:27], s34 offen offset:2048
    buffer_load_dwordx4 v[36:39], v3, s[24:27], s34 offen offset:3072
    buffer_load_dwordx4 v[40:43], v3, s[24:27], s35 offen offset:0
    s_add_u32 s52, s60, 4
    s_call_b64 s[98:99], K2_red
    s_lshl_b32 s45, s60, 2
    s_add_u32 s45, s45, 110336
    v_mov_b32 v2, s45
    s_mul_i32 s45, s60, 9216
    s_add_u32 s45, s45, 110592
    v_add_u32 v5, s45, v3
K2_hw:
    ds_read_b32 v4, v2
    s_waitcnt lgkmcnt(0)
    v_readfirstlane_b32 s46, v4
    s_cmp_lg_u32 s46, 0
    s_cbranch_scc1 K2_ho
    s_sleep 3
    s_branch K2_hw
K2_ho:
    ds_read_b128 v[132:135], v5 offset:0
    ds_read_b128 v[136:139], v5 offset:1024
    ds_read_b128 v[140:143], v5 offset:2048
    ds_read_b128 v[144:147], v5 offset:3072
    ds_read_b128 v[148:151], v5 offset:4096
    ds_read_b128 v[152:155], v5 offset:5120
    ds_read_b128 v[156:159], v5 offset:6144
    ds_read_b128 v[160:163], v5 offset:7168
    ds_read_b128 v[164:167], v5 offset:8192
    s_branch K2_tail
K2_opw:
    v_mov_b32 v96, 0
    v_mov_b32 v97, 0
    v_mov_b32 v98, 0
    v_mov_b32 v99, 0
    v_mov_b32 v100, 0
    v_mov_b32 v101, 0
    v_mov_b32 v102, 0
    v_mov_b32 v103, 0
    v_mov_b32 v104, 0
    v_mov_b32 v105, 0
    v_mov_b32 v106, 0
    v_mov_b32 v107, 0
    v_mov_b32 v108, 0
    v_mov_b32 v109, 0
    v_mov_b32 v110, 0
    v_mov_b32 v111, 0
    v_mov_b32 v112, 0
    v_mov_b32 v113, 0
    v_mov_b32 v114, 0
    v_mov_b32 v115, 0
    v_mov_b32 v116, 0
    v_mov_b32 v117, 0
    v_mov_b32 v118, 0
    v_mov_b32 v119, 0
    v_mov_b32 v120, 0
    v_mov_b32 v121, 0
    v_mov_b32 v122, 0
    v_mov_b32 v123, 0
    v_mov_b32 v124, 0
    v_mov_b32 v125, 0
    v_mov_b32 v126, 0
    v_mov_b32 v127, 0
    v_mov_b32 v128, 0
    v_mov_b32 v129, 0
    v_mov_b32 v130, 0
    v_mov_b32 v131, 0
    v_mov_b32 v132, 0
    v_mov_b32 v133, 0
    v_mov_b32 v134, 0
    v_mov_b32 v135, 0
    v_mov_b32 v136, 0
    v_mov_b32 v137, 0
    v_mov_b32 v138, 0
    v_mov_b32 v139, 0
    v_mov_b32 v140, 0
    v_mov_b32 v141, 0
    v_mov_b32 v142, 0
    v_mov_b32 v143, 0
    v_mov_b32 v144, 0
    v_mov_b32 v145, 0
    v_mov_b32 v146, 0
    v_mov_b32 v147, 0
    v_mov_b32 v148, 0
    v_mov_b32 v149, 0
    v_mov_b32 v150, 0
    v_mov_b32 v151, 0
    v_mov_b32 v152, 0
    v_mov_b32 v153, 0
    v_mov_b32 v154, 0
    v_mov_b32 v155, 0
    v_mov_b32 v156, 0
    v_mov_b32 v157, 0
    v_mov_b32 v158, 0
    v_mov_b32 v159, 0
    v_mov_b32 v160, 0
    v_mov_b32 v161, 0
    v_mov_b32 v162, 0
    v_mov_b32 v163, 0
    v_mov_b32 v164, 0
    v_mov_b32 v165, 0
    v_mov_b32 v166, 0
    v_mov_b32 v167, 0
    v_add_u32 v2, 98304, v3
    ds_write_b128 v2, v[96:99]
    ds_write_b128 v2, v[96:99] offset:1024
    s_mul_i32 s33, s60, 18432
    s_add_u32 s33, s33, 7733248
    s_mov_b32 s57, 0
    s_mov_b32 s54, -1
    v_mov_b32 v2, 110364
K2_kvw2:
    s_sleep 8
    ds_read_b32 v4, v2
    s_waitcnt lgkmcnt(0)
    v_readfirstlane_b32 s46, v4
    s_cmp_lt_u32 s46, 4
    s_cbranch_scc1 K2_kvw2
    s_add_u32 s34, s33, 0
    buffer_load_dwordx4 v[8:11], v3, s[24:27], s34 offen offset:0
    buffer_load_dwordx4 v[12:15], v3, s[24:27], s34 offen offset:1024
    buffer_load_dwordx4 v[16:19], v3, s[24:27], s34 offen offset:2048
    buffer_load_dwordx4 v[20:23], v3, s[24:27], s34 offen offset:3072
    s_add_u32 s34, s33, 4096
    buffer_load_dwordx4 v[24:27], v3, s[24:27], s34 offen offset:0
    buffer_load_dwordx4 v[28:31], v3, s[24:27], s34 offen offset:1024
    buffer_load_dwordx4 v[32:35], v3, s[24:27], s34 offen offset:2048
    buffer_load_dwordx4 v[36:39], v3, s[24:27], s34 offen offset:3072
    s_add_u32 s34, s33, 8192
    buffer_load_dwordx4 v[40:43], v3, s[24:27], s34 offen offset:0
    buffer_load_dwordx4 v[44:47], v3, s[24:27], s34 offen offset:1024
    buffer_load_dwordx4 v[48:51], v3, s[24:27], s34 offen offset:2048
    buffer_load_dwordx4 v[52:55], v3, s[24:27], s34 offen offset:3072
K2_ks:
    s_lshl_b32 s45, s57, 5
    s_add_u32 s45, s45, 31
    s_mul_i32 s45, s45, 911
    s_lshr_b32 s45, s45, 16
    s_cmp_eq_u32 s45, s54
    s_cbranch_scc1 K2_oo0
    s_cmp_eq_u32 s45, 4
    s_cbranch_scc1 K2_opd
    s_mov_b32 s54, s45
    s_and_b32 s46, s45, 1
    s_cmp_lg_u32 s46, s60
    s_cbranch_scc1 K2_nr0
    s_mov_b32 s52, s45
    s_call_b64 s[98:99], K2_red
    s_branch K2_oo0
K2_nr0:
    s_lshl_b32 s46, s54, 2
    s_add_u32 s46, s46, 110400
    v_mov_b32 v2, s46
K2_ow0:
    ds_read_b32 v4, v2
    s_waitcnt lgkmcnt(0)
    v_readfirstlane_b32 s46, v4
    s_cmp_lg_u32 s46, 0
    s_cbranch_scc1 K2_oo0
    s_sleep 3
    s_branch K2_ow0
K2_oo0:
    ds_read_b128 v[4:7], v0
    v_add_u32 v0, 64, v0
    s_add_u32 s57, s57, 1
    s_waitcnt lgkmcnt(0)
    s_waitcnt vmcnt(9)
    v_mfma_f32_16x16x32_bf16 v[96:99], v[8:11], v[4:7], v[96:99]
    v_mfma_f32_16x16x32_bf16 v[100:103], v[12:15], v[4:7], v[100:103]
    v_mfma_f32_16x16x32_bf16 v[104:107], v[16:19], v[4:7], v[104:107]
    s_add_u32 s34, s33, 12288
    buffer_load_dwordx4 v[8:11], v3, s[24:27], s34 offen offset:0
    buffer_load_dwordx4 v[12:15], v3, s[24:27], s34 offen offset:1024
    buffer_load_dwordx4 v[16:19], v3, s[24:27], s34 offen offset:2048
    s_waitcnt vmcnt(9)
    v_mfma_f32_16x16x32_bf16 v[108:111], v[20:23], v[4:7], v[108:111]
    v_mfma_f32_16x16x32_bf16 v[112:115], v[24:27], v[4:7], v[112:115]
    v_mfma_f32_16x16x32_bf16 v[116:119], v[28:31], v[4:7], v[116:119]
    buffer_load_dwordx4 v[20:23], v3, s[24:27], s34 offen offset:3072
    s_add_u32 s34, s33, 16384
    buffer_load_dwordx4 v[24:27], v3, s[24:27], s34 offen offset:0
    buffer_load_dwordx4 v[28:31], v3, s[24:27], s34 offen offset:1024
    s_waitcnt vmcnt(9)
    v_mfma_f32_16x16x32_bf16 v[120:123], v[32:35], v[4:7], v[120:123]
    v_mfma_f32_16x16x32_bf16 v[124:127], v[36:39], v[4:7], v[124:127]
    v_mfma_f32_16x16x32_bf16 v[128:131], v[40:43], v[4:7], v[128:131]
    s_add_u32 s34, s33, 36864
    buffer_load_dwordx4 v[32:35], v3, s[24:27], s34 offen offset:0
    buffer_load_dwordx4 v[36:39], v3, s[24:27], s34 offen offset:1024
    buffer_load_dwordx4 v[40:43], v3, s[24:27], s34 offen offset:2048
    s_waitcnt vmcnt(9)
    v_mfma_f32_16x16x32_bf16 v[132:135], v[44:47], v[4:7], v[132:135]
    v_mfma_f32_16x16x32_bf16 v[136:139], v[48:51], v[4:7], v[136:139]
    v_mfma_f32_16x16x32_bf16 v[140:143], v[52:55], v[4:7], v[140:143]
    buffer_load_dwordx4 v[44:47], v3, s[24:27], s34 offen offset:3072
    s_add_u32 s34, s33, 40960
    buffer_load_dwordx4 v[48:51], v3, s[24:27], s34 offen offset:0
    buffer_load_dwordx4 v[52:55], v3, s[24:27], s34 offen offset:1024
    s_waitcnt vmcnt(9)
    v_mfma_f32_16x16x32_bf16 v[144:147], v[8:11], v[4:7], v[144:147]
    v_mfma_f32_16x16x32_bf16 v[148:151], v[12:15], v[4:7], v[148:151]
    v_mfma_f32_16x16x32_bf16 v[152:155], v[16:19], v[4:7], v[152:155]
    buffer_load_dwordx4 v[8:11], v3, s[24:27], s34 offen offset:2048
    buffer_load_dwordx4 v[12:15], v3, s[24:27], s34 offen offset:3072
    s_add_u32 s34, s33, 45056
    buffer_load_dwordx4 v[16:19], v3, s[24:27], s34 offen offset:0
    s_waitcnt vmcnt(9)
    v_mfma_f32_16x16x32_bf16 v[156:159], v[20:23], v[4:7], v[156:159]
    v_mfma_f32_16x16x32_bf16 v[160:163], v[24:27], v[4:7], v[160:163]
    v_mfma_f32_16x16x32_bf16 v[164:167], v[28:31], v[4:7], v[164:167]
    buffer_load_dwordx4 v[20:23], v3, s[24:27], s34 offen offset:1024
    buffer_load_dwordx4 v[24:27], v3, s[24:27], s34 offen offset:2048
    buffer_load_dwordx4 v[28:31], v3, s[24:27], s34 offen offset:3072
    s_lshl_b32 s45, s57, 5
    s_add_u32 s45, s45, 31
    s_mul_i32 s45, s45, 911
    s_lshr_b32 s45, s45, 16
    s_cmp_eq_u32 s45, s54
    s_cbranch_scc1 K2_oo1
    s_cmp_eq_u32 s45, 4
    s_cbranch_scc1 K2_opd
    s_mov_b32 s54, s45
    s_and_b32 s46, s45, 1
    s_cmp_lg_u32 s46, s60
    s_cbranch_scc1 K2_nr1
    s_mov_b32 s52, s45
    s_call_b64 s[98:99], K2_red
    s_branch K2_oo1
K2_nr1:
    s_lshl_b32 s46, s54, 2
    s_add_u32 s46, s46, 110400
    v_mov_b32 v2, s46
K2_ow1:
    ds_read_b32 v4, v2
    s_waitcnt lgkmcnt(0)
    v_readfirstlane_b32 s46, v4
    s_cmp_lg_u32 s46, 0
    s_cbranch_scc1 K2_oo1
    s_sleep 3
    s_branch K2_ow1
K2_oo1:
    ds_read_b128 v[4:7], v0
    v_add_u32 v0, 64, v0
    s_add_u32 s57, s57, 1
    s_waitcnt lgkmcnt(0)
    s_waitcnt vmcnt(9)
    v_mfma_f32_16x16x32_bf16 v[96:99], v[32:35], v[4:7], v[96:99]
    v_mfma_f32_16x16x32_bf16 v[100:103], v[36:39], v[4:7], v[100:103]
    v_mfma_f32_16x16x32_bf16 v[104:107], v[40:43], v[4:7], v[104:107]
    s_add_u32 s34, s33, 49152
    buffer_load_dwordx4 v[32:35], v3, s[24:27], s34 offen offset:0
    buffer_load_dwordx4 v[36:39], v3, s[24:27], s34 offen offset:1024
    buffer_load_dwordx4 v[40:43], v3, s[24:27], s34 offen offset:2048
    s_waitcnt vmcnt(9)
    v_mfma_f32_16x16x32_bf16 v[108:111], v[44:47], v[4:7], v[108:111]
    v_mfma_f32_16x16x32_bf16 v[112:115], v[48:51], v[4:7], v[112:115]
    v_mfma_f32_16x16x32_bf16 v[116:119], v[52:55], v[4:7], v[116:119]
    buffer_load_dwordx4 v[44:47], v3, s[24:27], s34 offen offset:3072
    s_add_u32 s34, s33, 53248
    buffer_load_dwordx4 v[48:51], v3, s[24:27], s34 offen offset:0
    buffer_load_dwordx4 v[52:55], v3, s[24:27], s34 offen offset:1024
    s_waitcnt vmcnt(9)
    v_mfma_f32_16x16x32_bf16 v[120:123], v[8:11], v[4:7], v[120:123]
    v_mfma_f32_16x16x32_bf16 v[124:127], v[12:15], v[4:7], v[124:127]
    v_mfma_f32_16x16x32_bf16 v[128:131], v[16:19], v[4:7], v[128:131]
    s_add_u32 s34, s33, 73728
    buffer_load_dwordx4 v[8:11], v3, s[24:27], s34 offen offset:0
    buffer_load_dwordx4 v[12:15], v3, s[24:27], s34 offen offset:1024
    buffer_load_dwordx4 v[16:19], v3, s[24:27], s34 offen offset:2048
    s_waitcnt vmcnt(9)
    v_mfma_f32_16x16x32_bf16 v[132:135], v[20:23], v[4:7], v[132:135]
    v_mfma_f32_16x16x32_bf16 v[136:139], v[24:27], v[4:7], v[136:139]
    v_mfma_f32_16x16x32_bf16 v[140:143], v[28:31], v[4:7], v[140:143]
    buffer_load_dwordx4 v[20:23], v3, s[24:27], s34 offen offset:3072
    s_add_u32 s34, s33, 77824
    buffer_load_dwordx4 v[24:27], v3, s[24:27], s34 offen offset:0
    buffer_load_dwordx4 v[28:31], v3, s[24:27], s34 offen offset:1024
    s_waitcnt vmcnt(9)
    v_mfma_f32_16x16x32_bf16 v[144:147], v[32:35], v[4:7], v[144:147]
    v_mfma_f32_16x16x32_bf16 v[148:151], v[36:39], v[4:7], v[148:151]
    v_mfma_f32_16x16x32_bf16 v[152:155], v[40:43], v[4:7], v[152:155]
    buffer_load_dwordx4 v[32:35], v3, s[24:27], s34 offen offset:2048
    buffer_load_dwordx4 v[36:39], v3, s[24:27], s34 offen offset:3072
    s_add_u32 s34, s33, 81920
    buffer_load_dwordx4 v[40:43], v3, s[24:27], s34 offen offset:0
    s_waitcnt vmcnt(9)
    v_mfma_f32_16x16x32_bf16 v[156:159], v[44:47], v[4:7], v[156:159]
    v_mfma_f32_16x16x32_bf16 v[160:163], v[48:51], v[4:7], v[160:163]
    v_mfma_f32_16x16x32_bf16 v[164:167], v[52:55], v[4:7], v[164:167]
    buffer_load_dwordx4 v[44:47], v3, s[24:27], s34 offen offset:1024
    buffer_load_dwordx4 v[48:51], v3, s[24:27], s34 offen offset:2048
    buffer_load_dwordx4 v[52:55], v3, s[24:27], s34 offen offset:3072
    s_add_u32 s33, s33, 73728
    s_branch K2_ks
K2_opd:
    s_mul_i32 s45, s60, 9216
    s_add_u32 s45, s45, 110592
    v_add_u32 v5, s45, v3
    s_lshl_b32 s45, s60, 2
    s_add_u32 s45, s45, 110336
    v_mov_b32 v2, s45
    v_mov_b32 v4, 1
    ds_write_b128 v5, v[96:99] offset:0
    ds_write_b128 v5, v[100:103] offset:1024
    ds_write_b128 v5, v[104:107] offset:2048
    ds_write_b128 v5, v[108:111] offset:3072
    ds_write_b128 v5, v[112:115] offset:4096
    ds_write_b128 v5, v[116:119] offset:5120
    ds_write_b128 v5, v[120:123] offset:6144
    ds_write_b128 v5, v[124:127] offset:7168
    ds_write_b128 v5, v[128:131] offset:8192
    ds_write_b32 v2, v4
    s_lshl_b32 s32, s60, 1
    s_add_u32 s32, s32, 1
    s_waitcnt vmcnt(0) lgkmcnt(0)
    s_mul_i32 s33, s32, 9216
    s_add_u32 s33, s33, 8028160
    s_add_u32 s33, s33, 36864
    s_add_u32 s34, s33, 4096
    s_add_u32 s35, s33, 8192
    buffer_load_dwordx4 v[96:99], v3, s[24:27], s33 offen offset:0
    buffer_load_dwordx4 v[100:103], v3, s[24:27], s33 offen offset:1024
    buffer_load_dwordx4 v[104:107], v3, s[24:27], s33 offen offset:2048
    buffer_load_dwordx4 v[108:111], v3, s[24:27], s33 offen offset:3072
    buffer_load_dwordx4 v[112:115], v3, s[24:27], s34 offen offset:0
    buffer_load_dwordx4 v[116:119], v3, s[24:27], s34 offen offset:1024
    buffer_load_dwordx4 v[120:123], v3, s[24:27], s34 offen offset:2048
    buffer_load_dwordx4 v[124:127], v3, s[24:27], s34 offen offset:3072
    buffer_load_dwordx4 v[128:131], v3, s[24:27], s35 offen offset:0
    s_add_u32 s33, s33, 36864
    s_add_u32 s34, s33, 4096
    s_add_u32 s35, s33, 8192
    buffer_load_dwordx4 v[8:11], v3, s[24:27], s33 offen offset:0
    buffer_load_dwordx4 v[12:15], v3, s[24:27], s33 offen offset:1024
    buffer_load_dwordx4 v[16:19], v3, s[24:27], s33 offen offset:2048
    buffer_load_dwordx4 v[20:23], v3, s[24:27], s33 offen offset:3072
    buffer_load_dwordx4 v[24:27], v3, s[24:27], s34 offen offset:0
    buffer_load_dwordx4 v[28:31], v3, s[24:27], s34 offen offset:1024
    buffer_load_dwordx4 v[32:35], v3, s[24:27], s34 offen offset:2048
    buffer_load_dwordx4 v[36:39], v3, s[24:27], s34 offen offset:3072
    buffer_load_dwordx4 v[40:43], v3, s[24:27], s35 offen offset:0
K2_tail:
    v_and_b32 v0, 7, v1
    v_mul_u32_u24 v0, 1168, v0
    v_and_b32 v2, 48, v1
    v_add_u32 v0, v0, v2
    v_add_u32 v0, 100864, v0
    v_add_u32 v2, 98304, v2
    v_and_b32 v4, 8, v1
    v_cmp_ne_u32 vcc, 0, v4
    s_nop 1
    v_cndmask_b32 v0, v0, v2, vcc
    v_and_b32 v2, 15, v1
    v_mul_u32_u24 v7, 2304, v2
    v_lshrrev_b32 v5, 4, v1
    v_lshlrev_b32 v5, 3, v5
    v_add_u32 v7, v7, v5
    v_mov_b32 v6, 0x40000000
    v_cmp_lt_u32 vcc, 7, v2
    s_nop 1
    v_cndmask_b32 v7, v7, v6, vcc
    s_mul_i32 s65, s23, 18432
    s_mul_i32 s46, s32, 288
    s_add_u32 s65, s65, s46
    v_mov_b32 v2, 110416
K2_tw4:
    ds_read_b32 v4, v2
    s_waitcnt lgkmcnt(0)
    v_readfirstlane_b32 s46, v4
    s_cmp_lg_u32 s46, 0
    s_cbranch_scc1 K2_to4
    s_sleep 2
    s_branch K2_tw4
K2_to4:
    ds_read_b128 v[44:47], v0 offset:576
    ds_read_b128 v[48:51], v0 offset:640
    s_add_u32 s33, s33, 36864
    s_add_u32 s34, s33, 4096
    s_add_u32 s35, s33, 8192
    s_waitcnt lgkmcnt(0)
    s_waitcnt vmcnt(15)
    v_mfma_f32_16x16x32_bf16 v[132:135], v[96:99], v[44:47], v[132:135]
    v_mfma_f32_16x16x32_bf16 v[136:139], v[100:103], v[44:47], v[136:139]
    v_mfma_f32_16x16x32_bf16 v[140:143], v[104:107], v[44:47], v[140:143]
    buffer_load_dwordx4 v[96:99], v3, s[24:27], s33 offen offset:0
    buffer_load_dwordx4 v[100:103], v3, s[24:27], s33 offen offset:1024
    buffer_load_dwordx4 v[104:107], v3, s[24:27], s33 offen offset:2048
    s_waitcnt vmcnt(15)
    v_mfma_f32_16x16x32_bf16 v[144:147], v[108:111], v[44:47], v[144:147]
    v_mfma_f32_16x16x32_bf16 v[148:151], v[112:115], v[44:47], v[148:151]
    v_mfma_f32_16x16x32_bf16 v[152:155], v[116:119], v[44:47], v[152:155]
    buffer_load_dwordx4 v[108:111], v3, s[24:27], s33 offen offset:3072
    buffer_load_dwordx4 v[112:115], v3, s[24:27], s34 offen offset:0
    buffer_load_dwordx4 v[116:119], v3, s[24:27], s34 offen offset:1024
    s_waitcnt vmcnt(15)
    v_mfma_f32_16x16x32_bf16 v[156:159], v[120:123], v[44:47], v[156:159]
    v_mfma_f32_16x16x32_bf16 v[160:163], v[124:127], v[44:47], v[160:163]
    v_mfma_f32_16x16x32_bf16 v[164:167], v[128:131], v[44:47], v[164:167]
    buffer_load_dwordx4 v[120:123], v3, s[24:27], s34 offen offset:2048
    buffer_load_dwordx4 v[124:127], v3, s[24:27], s34 offen offset:3072
    buffer_load_dwordx4 v[128:131], v3, s[24:27], s35 offen offset:0
    s_add_u32 s33, s33, 36864
    s_add_u32 s34, s33, 4096
    s_add_u32 s35, s33, 8192
    s_waitcnt vmcnt(15)
    v_mfma_f32_16x16x32_bf16 v[132:135], v[8:11], v[48:51], v[132:135]
    v_mfma_f32_16x16x32_bf16 v[136:139], v[12:15], v[48:51], v[136:139]
    v_mfma_f32_16x16x32_bf16 v[140:143], v[16:19], v[48:51], v[140:143]
    buffer_load_dwordx4 v[8:11], v3, s[24:27], s33 offen offset:0
    buffer_load_dwordx4 v[12:15], v3, s[24:27], s33 offen offset:1024
    buffer_load_dwordx4 v[16:19], v3, s[24:27], s33 offen offset:2048
    s_waitcnt vmcnt(15)
    v_mfma_f32_16x16x32_bf16 v[144:147], v[20:23], v[48:51], v[144:147]
    v_mfma_f32_16x16x32_bf16 v[148:151], v[24:27], v[48:51], v[148:151]
    v_mfma_f32_16x16x32_bf16 v[152:155], v[28:31], v[48:51], v[152:155]
    buffer_load_dwordx4 v[20:23], v3, s[24:27], s33 offen offset:3072
    buffer_load_dwordx4 v[24:27], v3, s[24:27], s34 offen offset:0
    buffer_load_dwordx4 v[28:31], v3, s[24:27], s34 offen offset:1024
    s_waitcnt vmcnt(15)
    v_mfma_f32_16x16x32_bf16 v[156:159], v[32:35], v[48:51], v[156:159]
    v_mfma_f32_16x16x32_bf16 v[160:163], v[36:39], v[48:51], v[160:163]
    v_mfma_f32_16x16x32_bf16 v[164:167], v[40:43], v[48:51], v[164:167]
    buffer_load_dwordx4 v[32:35], v3, s[24:27], s34 offen offset:2048
    buffer_load_dwordx4 v[36:39], v3, s[24:27], s34 offen offset:3072
    buffer_load_dwordx4 v[40:43], v3, s[24:27], s35 offen offset:0
    v_mov_b32 v2, 110420
K2_tw5:
    ds_read_b32 v4, v2
    s_waitcnt lgkmcnt(0)
    v_readfirstlane_b32 s46, v4
    s_cmp_lg_u32 s46, 0
    s_cbranch_scc1 K2_to5
    s_sleep 2
    s_branch K2_tw5
K2_to5:
    ds_read_b128 v[44:47], v0 offset:704
    ds_read_b128 v[48:51], v0 offset:768
    s_add_u32 s33, s33, 36864
    s_add_u32 s34, s33, 4096
    s_add_u32 s35, s33, 8192
    s_waitcnt lgkmcnt(0)
    s_waitcnt vmcnt(15)
    v_mfma_f32_16x16x32_bf16 v[132:135], v[96:99], v[44:47], v[132:135]
    v_mfma_f32_16x16x32_bf16 v[136:139], v[100:103], v[44:47], v[136:139]
    v_mfma_f32_16x16x32_bf16 v[140:143], v[104:107], v[44:47], v[140:143]
    buffer_load_dwordx4 v[96:99], v3, s[24:27], s33 offen offset:0
    buffer_load_dwordx4 v[100:103], v3, s[24:27], s33 offen offset:1024
    buffer_load_dwordx4 v[104:107], v3, s[24:27], s33 offen offset:2048
    s_waitcnt vmcnt(15)
    v_mfma_f32_16x16x32_bf16 v[144:147], v[108:111], v[44:47], v[144:147]
    v_mfma_f32_16x16x32_bf16 v[148:151], v[112:115], v[44:47], v[148:151]
    v_mfma_f32_16x16x32_bf16 v[152:155], v[116:119], v[44:47], v[152:155]
    buffer_load_dwordx4 v[108:111], v3, s[24:27], s33 offen offset:3072
    buffer_load_dwordx4 v[112:115], v3, s[24:27], s34 offen offset:0
    buffer_load_dwordx4 v[116:119], v3, s[24:27], s34 offen offset:1024
    s_waitcnt vmcnt(15)
    v_mfma_f32_16x16x32_bf16 v[156:159], v[120:123], v[44:47], v[156:159]
    v_mfma_f32_16x16x32_bf16 v[160:163], v[124:127], v[44:47], v[160:163]
    v_mfma_f32_16x16x32_bf16 v[164:167], v[128:131], v[44:47], v[164:167]
    buffer_load_dwordx4 v[120:123], v3, s[24:27], s34 offen offset:2048
    buffer_load_dwordx4 v[124:127], v3, s[24:27], s34 offen offset:3072
    buffer_load_dwordx4 v[128:131], v3, s[24:27], s35 offen offset:0
    s_add_u32 s33, s33, 36864
    s_add_u32 s34, s33, 4096
    s_add_u32 s35, s33, 8192
    s_waitcnt vmcnt(15)
    v_mfma_f32_16x16x32_bf16 v[132:135], v[8:11], v[48:51], v[132:135]
    v_mfma_f32_16x16x32_bf16 v[136:139], v[12:15], v[48:51], v[136:139]
    v_mfma_f32_16x16x32_bf16 v[140:143], v[16:19], v[48:51], v[140:143]
    buffer_load_dwordx4 v[8:11], v3, s[24:27], s33 offen offset:0
    buffer_load_dwordx4 v[12:15], v3, s[24:27], s33 offen offset:1024
    buffer_load_dwordx4 v[16:19], v3, s[24:27], s33 offen offset:2048
    s_waitcnt vmcnt(15)
    v_mfma_f32_16x16x32_bf16 v[144:147], v[20:23], v[48:51], v[144:147]
    v_mfma_f32_16x16x32_bf16 v[148:151], v[24:27], v[48:51], v[148:151]
    v_mfma_f32_16x16x32_bf16 v[152:155], v[28:31], v[48:51], v[152:155]
    buffer_load_dwordx4 v[20:23], v3, s[24:27], s33 offen offset:3072
    buffer_load_dwordx4 v[24:27], v3, s[24:27], s34 offen offset:0
    buffer_load_dwordx4 v[28:31], v3, s[24:27], s34 offen offset:1024
    s_waitcnt vmcnt(15)
    v_mfma_f32_16x16x32_bf16 v[156:159], v[32:35], v[48:51], v[156:159]
    v_mfma_f32_16x16x32_bf16 v[160:163], v[36:39], v[48:51], v[160:163]
    v_mfma_f32_16x16x32_bf16 v[164:167], v[40:43], v[48:51], v[164:167]
    buffer_load_dwordx4 v[32:35], v3, s[24:27], s34 offen offset:2048
    buffer_load_dwordx4 v[36:39], v3, s[24:27], s34 offen offset:3072
    buffer_load_dwordx4 v[40:43], v3, s[24:27], s35 offen offset:0
    s_cmp_lg_u32 s32, 1
    s_cbranch_scc1 K2_tn6
    s_mov_b32 s52, 6
    s_call_b64 s[98:99], K2_red
K2_tn6:
    v_mov_b32 v2, 110424
K2_tw6:
    ds_read_b32 v4, v2
    s_waitcnt lgkmcnt(0)
    v_readfirstlane_b32 s46, v4
    s_cmp_lg_u32 s46, 0
    s_cbranch_scc1 K2_to6
    s_sleep 2
    s_branch K2_tw6
K2_to6:
    ds_read_b128 v[44:47], v0 offset:832
    ds_read_b128 v[48:51], v0 offset:896
    s_add_u32 s33, s33, 36864
    s_add_u32 s34, s33, 4096
    s_add_u32 s35, s33, 8192
    s_waitcnt lgkmcnt(0)
    s_waitcnt vmcnt(15)
    v_mfma_f32_16x16x32_bf16 v[132:135], v[96:99], v[44:47], v[132:135]
    v_mfma_f32_16x16x32_bf16 v[136:139], v[100:103], v[44:47], v[136:139]
    v_mfma_f32_16x16x32_bf16 v[140:143], v[104:107], v[44:47], v[140:143]
    buffer_load_dwordx4 v[96:99], v3, s[24:27], s33 offen offset:0
    buffer_load_dwordx4 v[100:103], v3, s[24:27], s33 offen offset:1024
    buffer_load_dwordx4 v[104:107], v3, s[24:27], s33 offen offset:2048
    s_waitcnt vmcnt(15)
    v_mfma_f32_16x16x32_bf16 v[144:147], v[108:111], v[44:47], v[144:147]
    v_mfma_f32_16x16x32_bf16 v[148:151], v[112:115], v[44:47], v[148:151]
    v_mfma_f32_16x16x32_bf16 v[152:155], v[116:119], v[44:47], v[152:155]
    buffer_load_dwordx4 v[108:111], v3, s[24:27], s33 offen offset:3072
    buffer_load_dwordx4 v[112:115], v3, s[24:27], s34 offen offset:0
    buffer_load_dwordx4 v[116:119], v3, s[24:27], s34 offen offset:1024
    s_waitcnt vmcnt(15)
    v_mfma_f32_16x16x32_bf16 v[156:159], v[120:123], v[44:47], v[156:159]
    v_mfma_f32_16x16x32_bf16 v[160:163], v[124:127], v[44:47], v[160:163]
    v_mfma_f32_16x16x32_bf16 v[164:167], v[128:131], v[44:47], v[164:167]
    buffer_load_dwordx4 v[120:123], v3, s[24:27], s34 offen offset:2048
    buffer_load_dwordx4 v[124:127], v3, s[24:27], s34 offen offset:3072
    buffer_load_dwordx4 v[128:131], v3, s[24:27], s35 offen offset:0
    s_add_u32 s33, s33, 36864
    s_add_u32 s34, s33, 4096
    s_add_u32 s35, s33, 8192
    s_waitcnt vmcnt(15)
    v_mfma_f32_16x16x32_bf16 v[132:135], v[8:11], v[48:51], v[132:135]
    v_mfma_f32_16x16x32_bf16 v[136:139], v[12:15], v[48:51], v[136:139]
    v_mfma_f32_16x16x32_bf16 v[140:143], v[16:19], v[48:51], v[140:143]
    buffer_load_dwordx4 v[8:11], v3, s[24:27], s33 offen offset:0
    buffer_load_dwordx4 v[12:15], v3, s[24:27], s33 offen offset:1024
    buffer_load_dwordx4 v[16:19], v3, s[24:27], s33 offen offset:2048
    s_waitcnt vmcnt(15)
    v_mfma_f32_16x16x32_bf16 v[144:147], v[20:23], v[48:51], v[144:147]
    v_mfma_f32_16x16x32_bf16 v[148:151], v[24:27], v[48:51], v[148:151]
    v_mfma_f32_16x16x32_bf16 v[152:155], v[28:31], v[48:51], v[152:155]
    buffer_load_dwordx4 v[20:23], v3, s[24:27], s33 offen offset:3072
    buffer_load_dwordx4 v[24:27], v3, s[24:27], s34 offen offset:0
    buffer_load_dwordx4 v[28:31], v3, s[24:27], s34 offen offset:1024
    s_waitcnt vmcnt(15)
    v_mfma_f32_16x16x32_bf16 v[156:159], v[32:35], v[48:51], v[156:159]
    v_mfma_f32_16x16x32_bf16 v[160:163], v[36:39], v[48:51], v[160:163]
    v_mfma_f32_16x16x32_bf16 v[164:167], v[40:43], v[48:51], v[164:167]
    buffer_load_dwordx4 v[32:35], v3, s[24:27], s34 offen offset:2048
    buffer_load_dwordx4 v[36:39], v3, s[24:27], s34 offen offset:3072
    buffer_load_dwordx4 v[40:43], v3, s[24:27], s35 offen offset:0
    s_add_u32 s33, s33, 36864
    s_add_u32 s34, s33, 4096
    s_add_u32 s35, s33, 8192
    buffer_load_dwordx4 v[56:59], v3, s[24:27], s33 offen offset:0
    buffer_load_dwordx4 v[60:63], v3, s[24:27], s33 offen offset:1024
    buffer_load_dwordx4 v[64:67], v3, s[24:27], s33 offen offset:2048
    buffer_load_dwordx4 v[68:71], v3, s[24:27], s33 offen offset:3072
    buffer_load_dwordx4 v[72:75], v3, s[24:27], s34 offen offset:0
    buffer_load_dwordx4 v[76:79], v3, s[24:27], s34 offen offset:1024
    buffer_load_dwordx4 v[80:83], v3, s[24:27], s34 offen offset:2048
    buffer_load_dwordx4 v[84:87], v3, s[24:27], s34 offen offset:3072
    buffer_load_dwordx4 v[88:91], v3, s[24:27], s35 offen offset:0
    s_barrier
    ds_read_b128 v[44:47], v0 offset:960
    ds_read_b128 v[48:51], v0 offset:1024
    ds_read_b128 v[52:55], v0 offset:1088
    s_waitcnt lgkmcnt(0)
    s_waitcnt vmcnt(15)
    v_mfma_f32_16x16x32_bf16 v[132:135], v[96:99], v[44:47], v[132:135]
    v_mfma_f32_16x16x32_bf16 v[136:139], v[100:103], v[44:47], v[136:139]
    v_mfma_f32_16x16x32_bf16 v[140:143], v[104:107], v[44:47], v[140:143]
    s_waitcnt vmcnt(12)
    v_mfma_f32_16x16x32_bf16 v[144:147], v[108:111], v[44:47], v[144:147]
    v_mfma_f32_16x16x32_bf16 v[148:151], v[112:115], v[44:47], v[148:151]
    v_mfma_f32_16x16x32_bf16 v[152:155], v[116:119], v[44:47], v[152:155]
    s_waitcnt vmcnt(9)
    v_mfma_f32_16x16x32_bf16 v[156:159], v[120:123], v[44:47], v[156:159]
    v_mfma_f32_16x16x32_bf16 v[160:163], v[124:127], v[44:47], v[160:163]
    v_mfma_f32_16x16x32_bf16 v[164:167], v[128:131], v[44:47], v[164:167]
    s_waitcnt vmcnt(15)
    v_mfma_f32_16x16x32_bf16 v[132:135], v[8:11], v[48:51], v[132:135]
    v_mfma_f32_16x16x32_bf16 v[136:139], v[12:15], v[48:51], v[136:139]
    v_mfma_f32_16x16x32_bf16 v[140:143], v[16:19], v[48:51], v[140:143]
    s_waitcnt vmcnt(12)
    v_mfma_f32_16x16x32_bf16 v[144:147], v[20:23], v[48:51], v[144:147]
    v_mfma_f32_16x16x32_bf16 v[148:151], v[24:27], v[48:51], v[148:151]
    v_mfma_f32_16x16x32_bf16 v[152:155], v[28:31], v[48:51], v[152:155]
    s_waitcnt vmcnt(9)
    v_mfma_f32_16x16x32_bf16 v[156:159], v[32:35], v[48:51], v[156:159]
    v_mfma_f32_16x16x32_bf16 v[160:163], v[36:39], v[48:51], v[160:163]
    v_mfma_f32_16x16x32_bf16 v[164:167], v[40:43], v[48:51], v[164:167]
    s_waitcnt vmcnt(6)
    v_mfma_f32_16x16x32_bf16 v[132:135], v[56:59], v[52:55], v[132:135]
    v_mfma_f32_16x16x32_bf16 v[136:139], v[60:63], v[52:55], v[136:139]
    v_mfma_f32_16x16x32_bf16 v[140:143], v[64:67], v[52:55], v[140:143]
    s_waitcnt vmcnt(3)
    v_mfma_f32_16x16x32_bf16 v[144:147], v[68:71], v[52:55], v[144:147]
    v_mfma_f32_16x16x32_bf16 v[148:151], v[72:75], v[52:55], v[148:151]
    v_mfma_f32_16x16x32_bf16 v[152:155], v[76:79], v[52:55], v[152:155]
    s_waitcnt vmcnt(0)
    v_mfma_f32_16x16x32_bf16 v[156:159], v[80:83], v[52:55], v[156:159]
    v_mfma_f32_16x16x32_bf16 v[160:163], v[84:87], v[52:55], v[160:163]
    v_mfma_f32_16x16x32_bf16 v[164:167], v[88:91], v[52:55], v[164:167]
    v_cvt_pk_bf16_f32 v8, v132, v133
    v_cvt_pk_bf16_f32 v9, v134, v135
    buffer_store_dwordx2 v[8:9], v7, s[36:39], s65 offen offset:0
    v_cvt_pk_bf16_f32 v10, v136, v137
    v_cvt_pk_bf16_f32 v11, v138, v139
    buffer_store_dwordx2 v[10:11], v7, s[36:39], s65 offen offset:32
    v_cvt_pk_bf16_f32 v12, v140, v141
    v_cvt_pk_bf16_f32 v13, v142, v143
    buffer_store_dwordx2 v[12:13], v7, s[36:39], s65 offen offset:64
    v_cvt_pk_bf16_f32 v14, v144, v145
    v_cvt_pk_bf16_f32 v15, v146, v147
    buffer_store_dwordx2 v[14:15], v7, s[36:39], s65 offen offset:96
    v_cvt_pk_bf16_f32 v16, v148, v149
    v_cvt_pk_bf16_f32 v17, v150, v151
    buffer_store_dwordx2 v[16:17], v7, s[36:39], s65 offen offset:128
    v_cvt_pk_bf16_f32 v18, v152, v153
    v_cvt_pk_bf16_f32 v19, v154, v155
    buffer_store_dwordx2 v[18:19], v7, s[36:39], s65 offen offset:160
    v_cvt_pk_bf16_f32 v20, v156, v157
    v_cvt_pk_bf16_f32 v21, v158, v159
    buffer_store_dwordx2 v[20:21], v7, s[36:39], s65 offen offset:192
    v_cvt_pk_bf16_f32 v22, v160, v161
    v_cvt_pk_bf16_f32 v23, v162, v163
    buffer_store_dwordx2 v[22:23], v7, s[36:39], s65 offen offset:224
    v_cvt_pk_bf16_f32 v24, v164, v165
    v_cvt_pk_bf16_f32 v25, v166, v167
    buffer_store_dwordx2 v[24:25], v7, s[36:39], s65 offen offset:256
    s_branch K2_end
K2_red:
    s_and_b32 s46, s52, 3
    s_mul_i32 s46, s46, 20480
    s_add_u32 s46, s46, 16384
    v_add_u32 v80, s46, v3
    v_and_b32 v81, 0x1ff, v3
    v_add_u32 v81, s46, v81
    v_and_b32 v82, 7, v1
    v_mul_u32_u24 v82, 2560, v82
    v_add_u32 v82, s46, v82
    s_add_u32 s46, s52, 1
    v_mov_b32 v83, s46
K2_rw:
    ds_read_b32 v56, v82 offset:2060
    s_waitcnt lgkmcnt(0)
    v_cmp_gt_u32 vcc, v83, v56
    s_cbranch_vccz K2_ro
    s_sleep 3
    s_branch K2_rw
K2_ro:
    ds_read_b128 v[64:67], v81 offset:2048
    ds_read_b128 v[56:59], v80 offset:0
    ds_read_b128 v[60:63], v80 offset:1024
    ds_read_b128 v[76:79], v81 offset:4608
    ds_read_b128 v[68:71], v80 offset:2560
    ds_read_b128 v[72:75], v80 offset:3584
    ds_read_b128 v[92:95], v81 offset:7168
    ds_read_b128 v[84:87], v80 offset:5120
    ds_read_b128 v[88:91], v80 offset:6144
    s_waitcnt lgkmcnt(3)
    v_add_f32 v56, v56, v68
    v_add_f32 v57, v57, v69
    v_add_f32 v58, v58, v70
    v_add_f32 v59, v59, v71
    v_add_f32 v60, v60, v72
    v_add_f32 v61, v61, v73
    v_add_f32 v62, v62, v74
    v_add_f32 v63, v63, v75
    v_add_f32 v64, v64, v76
    v_add_f32 v65, v65, v77
    v_add_f32 v66, v66, v78
    ds_read_b128 v[76:79], v81 offset:9728
    ds_read_b128 v[68:71], v80 offset:7680
    ds_read_b128 v[72:75], v80 offset:8704
    s_waitcnt lgkmcnt(3)
    v_add_f32 v56, v56, v84
    v_add_f32 v57, v57, v85
    v_add_f32 v58, v58, v86
    v_add_f32 v59, v59, v87
    v_add_f32 v60, v60, v88
    v_add_f32 v61, v61, v89
    v_add_f32 v62, v62, v90
    v_add_f32 v63, v63, v91
    v_add_f32 v64, v64, v92
    v_add_f32 v65, v65, v93
    v_add_f32 v66, v66, v94
    ds_read_b128 v[92:95], v81 offset:12288
    ds_read_b128 v[84:87], v80 offset:10240
    ds_read_b128 v[88:91], v80 offset:11264
    s_waitcnt lgkmcnt(3)
    v_add_f32 v56, v56, v68
    v_add_f32 v57, v57, v69
    v_add_f32 v58, v58, v70
    v_add_f32 v59, v59, v71
    v_add_f32 v60, v60, v72
    v_add_f32 v61, v61, v73
    v_add_f32 v62, v62, v74
    v_add_f32 v63, v63, v75
    v_add_f32 v64, v64, v76
    v_add_f32 v65, v65, v77
    v_add_f32 v66, v66, v78
    ds_read_b128 v[76:79], v81 offset:14848
    ds_read_b128 v[68:71], v80 offset:12800
    ds_read_b128 v[72:75], v80 offset:13824
    s_waitcnt lgkmcnt(3)
    v_add_f32 v56, v56, v84
    v_add_f32 v57, v57, v85
    v_add_f32 v58, v58, v86
    v_add_f32 v59, v59, v87
    v_add_f32 v60, v60, v88
    v_add_f32 v61, v61, v89
    v_add_f32 v62, v62, v90
    v_add_f32 v63, v63, v91
    v_add_f32 v64, v64, v92
    v_add_f32 v65, v65, v93
    v_add_f32 v66, v66, v94
    ds_read_b128 v[92:95], v81 offset:17408
    ds_read_b128 v[84:87], v80 offset:15360
    ds_read_b128 v[88:91], v80 offset:16384
    s_waitcnt lgkmcnt(3)
    v_add_f32 v56, v56, v68
    v_add_f32 v57, v57, v69
    v_add_f32 v58, v58, v70
    v_add_f32 v59, v59, v71
    v_add_f32 v60, v60, v72
    v_add_f32 v61, v61, v73
    v_add_f32 v62, v62, v74
    v_add_f32 v63, v63, v75
    v_add_f32 v64, v64, v76
    v_add_f32 v65, v65, v77
    v_add_f32 v66, v66, v78
    ds_read_b128 v[76:79], v81 offset:19968
    ds_read_b128 v[68:71], v80 offset:17920
    ds_read_b128 v[72:75], v80 offset:18944
    s_waitcnt lgkmcnt(3)
    v_add_f32 v56, v56, v84
    v_add_f32 v57, v57, v85
    v_add_f32 v58, v58, v86
    v_add_f32 v59, v59, v87
    v_add_f32 v60, v60, v88
    v_add_f32 v61, v61, v89
    v_add_f32 v62, v62, v90
    v_add_f32 v63, v63, v91
    v_add_f32 v64, v64, v92
    v_add_f32 v65, v65, v93
    v_add_f32 v66, v66, v94
    v_and_b32 v80, 7, v1
    v_mul_u32_u24 v80, 1168, v80
    v_bfe_u32 v81, v1, 3, 2
    v_mul_u32_u24 v81, 36, v81
    v_add_u32 v80, v80, v81
    s_mul_i32 s46, s52, 144
    s_add_u32 s46, s46, 100864
    v_add_u32 v80, s46, v80
    v_lshrrev_b32 v81, 5, v1
    v_lshlrev_b32 v81, 3, v81
    v_add_u32 v81, v80, v81
    v_mov_b32 v82, 0x7b800000
    s_waitcnt lgkmcnt(0)
    v_add_f32 v66, v66, v78
    v_add_f32 v56, v56, v68
    v_add_f32 v57, v57, v69
    v_add_f32 v58, v58, v70
    v_add_f32 v59, v59, v71
    v_add_f32 v60, v60, v72
    v_add_f32 v61, v61, v73
    v_add_f32 v62, v62, v74
    v_add_f32 v63, v63, v75
    v_add_f32 v64, v64, v76
    v_add_f32 v65, v65, v77
    v_rcp_f32 v67, v66
    v_max3_f32 v83, |v56|, |v57|, |v58|
    v_max3_f32 v84, |v59|, |v60|, |v61|
    v_max3_f32 v85, |v62|, |v63|, |v64|
    v_add_f32 v86, v56, v57
    v_add_f32 v86, v86, v58
    v_add_f32 v86, v86, v59
    v_add_f32 v86, v86, v60
    v_add_f32 v86, v86, v61
    v_add_f32 v86, v86, v62
    v_add_f32 v86, v86, v63
    v_add_f32 v86, v86, v64
    v_add_f32 v86, v86, v65
    v_add_f32 v86, v86, v66
    v_max3_f32 v83, v83, v84, v85
    v_max3_f32 v83, v83, |v65|, |v66|
    v_cmp_nlt_f32 vcc, v83, v82
    v_cmp_u_f32 s[96:97], v86, v86
    s_or_b64 s[96:97], s[96:97], vcc
    v_mov_b32 v82, 0x2b800000
    v_cmp_nge_f32 vcc, v66, v82
    v_mul_f32 v56, v56, v67
    v_mul_f32 v57, v57, v67
    v_mul_f32 v58, v58, v67
    v_mul_f32 v59, v59, v67
    v_mul_f32 v60, v60, v67
    v_mul_f32 v61, v61, v67
    v_mul_f32 v62, v62, v67
    v_mul_f32 v63, v63, v67
    v_mul_f32 v64, v64, v67
    v_mul_f32 v65, v65, v67
    s_or_b64 s[96:97], s[96:97], vcc
    s_cbranch_scc1 K2_slow
K2_rfin:
    v_cvt_pk_bf16_f32 v68, v56, v57
    v_cvt_pk_bf16_f32 v69, v58, v59
    v_cvt_pk_bf16_f32 v70, v60, v61
    v_cvt_pk_bf16_f32 v71, v62, v63
    v_cvt_pk_bf16_f32 v72, v64, v65
    ds_write2_b32 v81, v68, v69 offset0:0 offset1:1
    ds_write2_b32 v81, v70, v71 offset0:4 offset1:5
    s_mov_b64 exec, s[58:59]
    ds_write_b32 v80, v72 offset:32
    s_mov_b64 exec, -1
    s_lshl_b32 s46, s52, 2
    s_add_u32 s46, s46, 110400
    v_mov_b32 v80, s46
    v_mov_b32 v81, 1
    ds_write_b32 v80, v81
    s_setpc_b64 s[98:99]
K2_slow:
    s_waitcnt vmcnt(0)
    s_lshl_b32 s101, s2, 4
    s_add_u32 s101, s101, s40
    s_mul_i32 s101, s101, 18432
    s_add_u32 s101, s101, 16777216
    s_mov_b32 s97, s101
    buffer_store_dwordx4 v[96:99], v3, s[24:27], s97 offen offset:0
    buffer_store_dwordx4 v[100:103], v3, s[24:27], s97 offen offset:1024
    buffer_store_dwordx4 v[104:107], v3, s[24:27], s97 offen offset:2048
    buffer_store_dwordx4 v[108:111], v3, s[24:27], s97 offen offset:3072
    s_add_u32 s97, s97, 4096
    buffer_store_dwordx4 v[112:115], v3, s[24:27], s97 offen offset:0
    buffer_store_dwordx4 v[116:119], v3, s[24:27], s97 offen offset:1024
    buffer_store_dwordx4 v[120:123], v3, s[24:27], s97 offen offset:2048
    buffer_store_dwordx4 v[124:127], v3, s[24:27], s97 offen offset:3072
    s_add_u32 s97, s97, 4096
    buffer_store_dwordx4 v[128:131], v3, s[24:27], s97 offen offset:0
    buffer_store_dwordx4 v[132:135], v3, s[24:27], s97 offen offset:1024
    buffer_store_dwordx4 v[136:139], v3, s[24:27], s97 offen offset:2048
    buffer_store_dwordx4 v[140:143], v3, s[24:27], s97 offen offset:3072
    s_add_u32 s97, s97, 4096
    buffer_store_dwordx4 v[144:147], v3, s[24:27], s97 offen offset:0
    buffer_store_dwordx4 v[148:151], v3, s[24:27], s97 offen offset:1024
    buffer_store_dwordx4 v[152:155], v3, s[24:27], s97 offen offset:2048
    buffer_store_dwordx4 v[156:159], v3, s[24:27], s97 offen offset:3072
    s_add_u32 s97, s97, 4096
    buffer_store_dwordx4 v[160:163], v3, s[24:27], s97 offen offset:0
    buffer_store_dwordx4 v[164:167], v3, s[24:27], s97 offen offset:1024
    s_waitcnt vmcnt(0)
    s_lshl_b32 s46, s52, 11
    v_add_u32 v152, s46, v3
    ds_read_b128 v[96:99], v152 offset:0
    ds_read_b32 v157, v152 offset:1024
    v_and_b32 v152, 31, v1
    v_lshlrev_b32 v159, 2, v152
    v_min_u32 v153, 18, v152
    v_mov_b32 v154, v153
    v_cmp_eq_u32 vcc, 4, v153
    s_nop 1
    v_cndmask_b32 v154, v154, 18, vcc
    v_cmp_eq_u32 vcc, 18, v153
    s_nop 1
    v_cndmask_b32 v154, v154, 4, vcc
    v_lshlrev_b32 v154, 4, v154
    v_lshrrev_b32 v153, 5, v1
    v_mul_u32_u24 v153, 304, v153
    v_add_u32 v158, v153, v154
    v_mov_b32 v156, 0xff800000
    v_mov_b32 v108, 0x3f803f80
    v_mov_b32 v109, 0x3f803f80
    s_mov_b32 s100, 0
    s_waitcnt lgkmcnt(0)
    v_cndmask_b32 v100, 0, v157, s[58:59]
    v_mov_b32 v101, 0
    v_mov_b32 v136, 0
    v_mov_b32 v137, 0
    v_mov_b32 v138, 0
    v_mov_b32 v139, 0
    v_mov_b32 v140, 0
    v_mov_b32 v141, 0
    v_mov_b32 v142, 0
    v_mov_b32 v143, 0
    v_mov_b32 v144, 0
    v_mov_b32 v145, 0
    v_mov_b32 v146, 0
    v_mov_b32 v147, 0
    v_mov_b32 v148, 0
    v_mov_b32 v149, 0
    v_mov_b32 v150, 0
    v_mov_b32 v151, 0
K2_zp:
    s_mov_b32 s96, 0
K2_zt:
    s_lshr_b32 s97, s96, 3
    s_lshl_b32 s97, s97, 9
    s_mul_i32 s46, s96, 2368
    s_add_u32 s97, s97, s46
    s_add_u32 s97, s97, 2359296
    buffer_load_dwordx4 v[104:107], v3, s[24:27], s97 offen
    buffer_load_dwordx4 v[112:115], v158, s[24:27], s97 offen offset:1152
    buffer_load_dwordx4 v[116:119], v158, s[24:27], s97 offen offset:1760
    s_mov_b64 exec, s[58:59]
    buffer_load_dword v108, v159, s[24:27], s97 offen offset:1024
    s_mov_b64 exec, -1
    s_waitcnt vmcnt(0)
    v_mfma_f32_32x32x16_bf16 v[120:135], v[104:107], v[96:99], 0
    v_mfma_f32_32x32x8_bf16 v[120:135], v[108:109], v[100:101], v[120:135]
    s_cmp_lg_u32 s100, 0
    s_cbranch_scc1 K2_z2
    s_nop 9
    v_max3_f32 v156, v156, v120, v121
    v_max3_f32 v156, v156, v122, v123
    v_max3_f32 v156, v156, v124, v125
    v_max3_f32 v156, v156, v126, v127
    v_max3_f32 v156, v156, v128, v129
    v_max3_f32 v156, v156, v130, v131
    v_max3_f32 v156, v156, v132, v133
    v_max3_f32 v156, v156, v134, v135
    s_branch K2_zn
K2_z2:
    s_nop 9
    v_exp_f32 v120, v120
    v_exp_f32 v121, v121
    v_exp_f32 v122, v122
    v_exp_f32 v123, v123
    v_exp_f32 v124, v124
    v_exp_f32 v125, v125
    v_exp_f32 v126, v126
    v_exp_f32 v127, v127
    v_exp_f32 v128, v128
    v_exp_f32 v129, v129
    v_exp_f32 v130, v130
    v_exp_f32 v131, v131
    v_exp_f32 v132, v132
    v_exp_f32 v133, v133
    v_exp_f32 v134, v134
    v_exp_f32 v135, v135
    v_cvt_pk_bf16_f32 v120, v120, v121
    v_cvt_pk_bf16_f32 v121, v122, v123
    v_cvt_pk_bf16_f32 v122, v124, v125
    v_cvt_pk_bf16_f32 v123, v126, v127
    v_cvt_pk_bf16_f32 v124, v128, v129
    v_cvt_pk_bf16_f32 v125, v130, v131
    v_cvt_pk_bf16_f32 v126, v132, v133
    v_cvt_pk_bf16_f32 v127, v134, v135
    v_mfma_f32_32x32x16_bf16 v[136:151], v[112:115], v[120:123], v[136:151]
    s_nop 0
    v_mfma_f32_32x32x16_bf16 v[136:151], v[116:119], v[124:127], v[136:151]
    s_nop 7
    s_nop 7
K2_zn:
    s_add_u32 s96, s96, 1
    s_cmp_lt_u32 s96, 64
    s_cbranch_scc1 K2_zt
    s_cmp_lg_u32 s100, 0
    s_cbranch_scc1 K2_zd
    v_mov_b32 v152, v156
    s_nop 1
    v_permlane32_swap_b32 v156, v152
    v_max_f32 v156, v156, v152
    v_sub_f32 v152, 0, v156
    v_and_b32 v153, 0xffff0000, v152
    v_sub_f32 v152, v152, v153
    v_and_b32 v154, 0xffff0000, v152
    v_sub_f32 v152, v152, v154
    v_lshrrev_b32 v153, 16, v153
    v_or_b32 v153, v153, v154
    v_lshrrev_b32 v152, 16, v152
    v_cndmask_b32 v100, v153, v157, s[58:59]
    v_cndmask_b32 v101, v152, 0, s[58:59]
    v_cndmask_b32 v102, v153, 0, s[58:59]
    v_cndmask_b32 v103, v152, v157, s[58:59]
    s_mov_b32 s100, 1
    s_branch K2_zp
K2_zd:
    v_rcp_f32 v152, v146
    s_nop 0
    v_mul_f32 v56, v136, v152
    v_mul_f32 v57, v137, v152
    v_mul_f32 v58, v138, v152
    v_mul_f32 v59, v139, v152
    v_mul_f32 v60, v140, v152
    v_mul_f32 v61, v141, v152
    v_mul_f32 v62, v142, v152
    v_mul_f32 v63, v143, v152
    v_mul_f32 v64, v144, v152
    v_mul_f32 v65, v145, v152
    buffer_load_dwordx4 v[96:99], v3, s[24:27], s101 offen offset:0 sc1
    buffer_load_dwordx4 v[100:103], v3, s[24:27], s101 offen offset:1024 sc1
    buffer_load_dwordx4 v[104:107], v3, s[24:27], s101 offen offset:2048 sc1
    buffer_load_dwordx4 v[108:111], v3, s[24:27], s101 offen offset:3072 sc1
    s_add_u32 s101, s101, 4096
    buffer_load_dwordx4 v[112:115], v3, s[24:27], s101 offen offset:0 sc1
    buffer_load_dwordx4 v[116:119], v3, s[24:27], s101 offen offset:1024 sc1
    buffer_load_dwordx4 v[120:123], v3, s[24:27], s101 offen offset:2048 sc1
    buffer_load_dwordx4 v[124:127], v3, s[24:27], s101 offen offset:3072 sc1
    s_add_u32 s101, s101, 4096
    buffer_load_dwordx4 v[128:131], v3, s[24:27], s101 offen offset:0 sc1
    buffer_load_dwordx4 v[132:135], v3, s[24:27], s101 offen offset:1024 sc1
    buffer_load_dwordx4 v[136:139], v3, s[24:27], s101 offen offset:2048 sc1
    buffer_load_dwordx4 v[140:143], v3, s[24:27], s101 offen offset:3072 sc1
    s_add_u32 s101, s101, 4096
    buffer_load_dwordx4 v[144:147], v3, s[24:27], s101 offen offset:0 sc1
    buffer_load_dwordx4 v[148:151], v3, s[24:27], s101 offen offset:1024 sc1
    buffer_load_dwordx4 v[152:155], v3, s[24:27], s101 offen offset:2048 sc1
    buffer_load_dwordx4 v[156:159], v3, s[24:27], s101 offen offset:3072 sc1
    s_add_u32 s101, s101, 4096
    buffer_load_dwordx4 v[160:163], v3, s[24:27], s101 offen offset:0 sc1
    buffer_load_dwordx4 v[164:167], v3, s[24:27], s101 offen offset:1024 sc1
    s_waitcnt vmcnt(0)
    s_branch K2_rfin
K2_end:
K2_exit:
    s_endpgm
K2_codeend:
.section .rodata,"a"
.p2align 6
.amdhsa_kernel k1_kernel
  .amdhsa_next_free_vgpr 168
  .amdhsa_next_free_sgpr 102
  .amdhsa_accum_offset 168
  .amdhsa_group_segment_fixed_size 0
  .amdhsa_kernarg_size 104
  .amdhsa_user_sgpr_count 2
  .amdhsa_user_sgpr_kernarg_segment_ptr 1
  .amdhsa_system_sgpr_workgroup_id_x 1
.end_amdhsa_kernel

.p2align 6
.amdhsa_kernel k2_kernel
  .amdhsa_next_free_vgpr 168
  .amdhsa_next_free_sgpr 102
  .amdhsa_accum_offset 168
  .amdhsa_group_segment_fixed_size 0
  .amdhsa_kernarg_size 104
  .amdhsa_user_sgpr_count 2
  .amdhsa_user_sgpr_kernarg_segment_ptr 1
  .amdhsa_system_sgpr_workgroup_id_x 1
.end_amdhsa_kernel
```
